```python
import torch

def _softmax(x, axis=-1):
    return torch.softmax(x, dim=axis)
def _gelu(x):
    return torch.nn.functional.gelu(x, approximate="tanh")
def _silu(x):
    return torch.nn.functional.silu(x)
def _sigmoid(x):
    return torch.sigmoid(x)
def _layernorm(x, axis=-1, eps=1e-5):
    m = x.mean(dim=axis, keepdim=True)
    v = x.var(dim=axis, keepdim=True, unbiased=False)
    return (x - m) / torch.sqrt(v + eps)
def _scatter_add(tgt, idx, src, axis=0):
    return tgt.clone().index_add_(axis, idx, src)
def _segment_sum(src, seg, n):
    out = torch.zeros((n,) + src.shape[1:], dtype=src.dtype)
    return out.index_add_(0, seg, src)
def _pad(x, pw):
    flat = tuple(v for pair in reversed(pw) for v in pair)
    return torch.nn.functional.pad(x, flat)

kernel_name = 'concat_heads__gqa_block_cached__gqa_block_cached__near_ridge'

def setup_inputs():

    _w = (lambda a: (lambda t: t.to(torch.bfloat16) if t.is_floating_point() else t)(torch.as_tensor(a)))
    def _A_setup():
        B, Sq, D = 16, 32, 1024
        Hq, Hkv, Sk, Dh = 32, 4, 1024, 128
        assert Hq % Hkv == 0, (Hq, Hkv)
        return {
            "x": _w((lambda *s: torch.randn(*s, dtype=torch.bfloat16) * 0.8)(B, Sq, D)),
            "k_cache": _w((lambda *s: torch.randn(*s, dtype=torch.bfloat16) * 0.8)(B, Hkv, Sk, Dh)),
            "v_cache": _w((lambda *s: torch.randn(*s, dtype=torch.bfloat16) * 0.05)(B, Hkv, Sk, Dh)),
            "wq": _w((lambda *s: torch.randn(*s, dtype=torch.bfloat16) * 0.8)(D, Hq * Dh) * (D ** -0.5)),
            "wo": _w((lambda *s: torch.randn(*s, dtype=torch.bfloat16) * 0.05)(Hq * Dh, D) * ((Hq * Dh) ** -0.5)),
        }
    _A_in = _A_setup()

    def _B_setup():
        B, Sq, D = 16, 32, 1024
        Hq, Hkv, Sk, Dh = 32, 4, 1024, 128
        assert Hq % Hkv == 0, (Hq, Hkv)
        return {
            "x": _w((lambda *s: torch.randn(*s, dtype=torch.bfloat16) * 0.8)(B, Sq, D)),
            "k_cache": _w((lambda *s: torch.randn(*s, dtype=torch.bfloat16) * 0.8)(B, Hkv, Sk, Dh)),
            "v_cache": _w((lambda *s: torch.randn(*s, dtype=torch.bfloat16) * 0.05)(B, Hkv, Sk, Dh)),
            "wq": _w((lambda *s: torch.randn(*s, dtype=torch.bfloat16) * 0.8)(D, Hq * Dh) * (D ** -0.5)),
            "wo": _w((lambda *s: torch.randn(*s, dtype=torch.bfloat16) * 0.05)(Hq * Dh, D) * ((Hq * Dh) ** -0.5)),
        }
    _B_in = _B_setup()

    return {
        "A_x": _A_in["x"],
        "A_k_cache": _A_in["k_cache"],
        "A_v_cache": _A_in["v_cache"],
        "A_wq": _A_in["wq"],
        "A_wo": _A_in["wo"],
        "B_x": _B_in["x"],
        "B_k_cache": _B_in["k_cache"],
        "B_v_cache": _B_in["v_cache"],
        "B_wq": _B_in["wq"],
        "B_wo": _B_in["wo"],
    }

def reference(A_x, A_k_cache, A_v_cache, A_wq, A_wo, B_x, B_k_cache, B_v_cache, B_wq, B_wo):
    def _A_ref(x, k_cache, v_cache, wq, wo):
        B, Sq, D = x.shape
        Hq, Dh = 32, 128
        Hkv = k_cache.shape[1]
        rep = Hq // Hkv
        q = (lambda x, *d: x.permute(*d))((x @ wq).reshape(B, Sq, Hq, Dh), 0, 2, 1, 3)
        k = (lambda x, n, axis: torch.repeat_interleave(x, n, dim=axis))(k_cache, rep, axis=1)
        v = (lambda x, n, axis: torch.repeat_interleave(x, n, dim=axis))(v_cache, rep, axis=1)
        scores = torch.einsum("bhqd,bhkd->bhqk", q, k) * (Dh ** -0.5)
        p = _softmax(scores, axis=-1)
        o = torch.einsum("bhqk,bhkd->bhqd", p, v)
        return (lambda x, *d: x.permute(*d))(o, 0, 2, 1, 3).reshape(B, Sq, Hq * Dh) @ wo

    def _B_ref(x, k_cache, v_cache, wq, wo):
        B, Sq, D = x.shape
        Hq, Dh = 32, 128
        Hkv = k_cache.shape[1]
        rep = Hq // Hkv
        q = (lambda x, *d: x.permute(*d))((x @ wq).reshape(B, Sq, Hq, Dh), 0, 2, 1, 3)
        k = (lambda x, n, axis: torch.repeat_interleave(x, n, dim=axis))(k_cache, rep, axis=1)
        v = (lambda x, n, axis: torch.repeat_interleave(x, n, dim=axis))(v_cache, rep, axis=1)
        scores = torch.einsum("bhqd,bhkd->bhqk", q, k) * (Dh ** -0.5)
        p = _softmax(scores, axis=-1)
        o = torch.einsum("bhqk,bhkd->bhqd", p, v)
        return (lambda x, *d: x.permute(*d))(o, 0, 2, 1, 3).reshape(B, Sq, Hq * Dh) @ wo

    a = _A_ref(A_x, A_k_cache, A_v_cache, A_wq, A_wo)
    b = _B_ref(B_x, B_k_cache, B_v_cache, B_wq, B_wo)
    return torch.concatenate([a, b], axis=-1)
```

```asm
; @launch grid=(256,1,1) block=(512,1,1) lds=163840
.amdgcn_target "amdgcn-amd-amdhsa--gfx950"
.text
.globl concat_heads__gqa_block_cached__gqa_block_cached__near_ridge_kernel
.p2align 8
.type concat_heads__gqa_block_cached__gqa_block_cached__near_ridge_kernel,@function
concat_heads__gqa_block_cached__gqa_block_cached__near_ridge_kernel:
    s_cmp_ge_u32 s2, 256
    s_cbranch_scc1 L_end
    s_bfe_u32 s32, s2, 0x10002
    s_mul_i32 s38, s32, 40
    s_add_u32 s39, s38, 32
    s_load_dwordx8 s[60:67], s[0:1], s38
    s_load_dwordx2 s[68:69], s[0:1], s39
    s_load_dwordx2 s[70:71], s[0:1], 80
    s_load_dwordx4 s[72:75], s[0:1], 88
    v_lshrrev_b32 v1, 6, v0
    s_and_b32 s30, s2, 7
    s_lshr_b32 s31, s2, 3
    v_readfirstlane_b32 s37, v1
    s_and_b32 s33, s30, 3
    v_and_b32 v0, 63, v0
    s_and_b32 s34, s31, 3
    s_lshr_b32 s35, s31, 2
    s_lshr_b32 s36, s37, 2
    s_cbranch_scc0 L_comp
    s_and_b32 s37, s37, 3
    v_lshrrev_b32 v32, 4, v0
    s_lshl_b32 s39, s37, 4
    v_add_u32 v33, s39, v32
    v_and_b32 v31, 15, v0
    v_lshlrev_b32 v35, 2, v32
    v_xor_b32 v35, v31, v35
    v_lshlrev_b32 v35, 4, v35
    s_lshl_b32 s42, s33, 3
    s_add_u32 s42, s42, s35
    s_lshl_b32 s42, s42, 8
    v_lshlrev_b32_e64 v30, 13, v33
    v_add3_u32 v2, v30, v35, s42
    v_add_u32 v3, 31744, v2
    v_add_u32 v4, 63488, v2
    v_add_u32 v5, 95232, v2
    v_xor_b32 v4, 16, v4
    v_xor_b32 v5, 16, v5
    s_lshl_b32 s42, s34, 7
    s_lshl_b32 s39, s37, 5
    s_add_u32 s42, s42, s39
    v_lshrrev_b32 v30, 3, v0
    v_add_u32 v30, s42, v30
    v_lshlrev_b32 v30, 11, v30
    v_and_b32 v34, 7, v0
    v_xor_b32 v34, v34, v32
    v_lshl_add_u32 v6, v34, 4, v30
    v_xor_b32_e64 v34, 4, v34
    v_lshl_add_u32 v7, v34, 4, v30
    v_add_u32 v7, 15360, v7
    v_add_u32 v8, 30720, v6
    v_add_u32 v9, 30720, v7
    s_lshl_b32 s44, s37, 12
    s_add_u32 s59, s34, s35
    s_bitcmp1_b32 s59, 0
    s_mov_b32 s42, 0x68532410
    s_cselect_b32 s42, 0x96435201, s42
    s_mov_b32 s43, 0x75463102
    s_cselect_b32 s43, 0x65742130, s43
    s_bitcmp1_b32 s59, 1
    s_cselect_b32 s50, s43, s42
    s_mov_b32 s6, 8388608
    s_mov_b32 s7, 0x20000
    s_mov_b32 s10, 1048576
    s_mov_b32 s11, 0x20000
    s_bfe_u32 s46, s50, 0x40000
    s_lshl_b32 s47, s46, 19
    s_lshl_b32 s48, s46, 7
    s_lshl_b32 s39, s32, 5
    s_add_u32 s39, s39, s31
    s_lshl_b32 s39, s39, 17
    s_add_u32 s39, s39, 16784384
    s_bitcmp1_b32 s31, 0
    s_cselect_b32 s39, 2097152, s39
    s_bitcmp1_b32 s31, 1
    s_cselect_b32 s39, s39, 0
    v_mov_b32 v10, s39
    s_bitcmp1_b32 s31, 0
    s_waitcnt lgkmcnt(0)
    s_cselect_b64 s[42:43], s[60:61], s[66:67]
    s_cselect_b64 s[40:41], s[66:67], s[74:75]
    s_bitcmp1_b32 s31, 1
    s_cselect_b64 s[42:43], s[40:41], s[42:43]
    global_load_dword v11, v10, s[42:43]
    s_mov_b64 s[4:5], s[66:67]
    s_mov_b64 s[8:9], s[60:61]
    s_add_u32 m0, s44, 0
    s_nop 0
    buffer_load_dwordx4 v2, s[4:7], s47 offen lds
    buffer_load_dwordx4 v3, s[4:7], s47 offen offset:1024 lds
    buffer_load_dwordx4 v4, s[4:7], s47 offen offset:2048 lds
    buffer_load_dwordx4 v5, s[4:7], s47 offen offset:3072 lds
    s_add_u32 m0, s44, 65536
    s_nop 0
    buffer_load_dwordx4 v6, s[8:11], s48 offen lds
    buffer_load_dwordx4 v7, s[8:11], s48 offen offset:1024 lds
    buffer_load_dwordx4 v8, s[8:11], s48 offen offset:2048 lds
    buffer_load_dwordx4 v9, s[8:11], s48 offen offset:3072 lds
    s_mov_b32 s12, s74
    s_mov_b32 s13, s75
    s_mov_b32 s14, 50331648
    s_mov_b32 s15, 0x20000
    s_bitcmp1_b32 s59, 0
    s_mov_b32 s42, 0xfedbac97
    s_cselect_b32 s42, 0xfecbda87, s42
    s_mov_b32 s43, 0xfdceb98a
    s_cselect_b32 s43, 0xedfca9b8, s43
    s_bitcmp1_b32 s59, 1
    s_cselect_b32 s51, s43, s42
    s_lshr_b32 s38, s31, 1
    s_lshl_b32 s45, s38, 10
    s_lshl_b32 s38, s38, 2
    s_add_u32 s38, s38, s33
    s_lshl_b32 s38, s38, 18
    s_add_u32 s62, s62, s38
    s_addc_u32 s63, s63, 0
    s_add_u32 s64, s64, s38
    s_addc_u32 s65, s65, 0
    s_mov_b32 s20, s62
    s_mov_b32 s21, s63
    s_mov_b32 s22, 262144
    s_mov_b32 s23, 0x20000
    s_mov_b32 s24, s64
    s_mov_b32 s25, s65
    s_mov_b32 s26, 262144
    s_mov_b32 s27, 0x20000
    v_lshlrev_b32 v34, 1, v32
    v_xor_b32 v35, v31, v34
    v_lshlrev_b32 v35, 4, v35
    v_xor_b32 v31, v31, v32
    v_add_u32 v36, 0, v33
    v_lshrrev_b32 v37, 2, v36
    v_and_b32 v36, 3, v36
    v_lshl_add_u32 v36, v37, 6, v36
    v_lshlrev_b32 v36, 8, v36
    v_subrev_u32 v36, 0, v36
    v_xor_b32_e64 v34, 0, v31
    v_lshl_add_u32 v12, v34, 4, v36
    v_add_u32 v26, v35, v36
    v_add_u32 v36, 4, v33
    v_lshrrev_b32 v37, 2, v36
    v_and_b32 v36, 3, v36
    v_lshl_add_u32 v36, v37, 6, v36
    v_lshlrev_b32_e64 v36, 8, v36
    v_subrev_u32 v36, 1024, v36
    v_xor_b32_e64 v34, 4, v31
    v_lshl_add_u32 v13, v34, 4, v36
    v_add_u32_e64 v27, v35, v36
    v_xor_b32 v27, 128, v27
    v_add_u32 v36, 8, v33
    v_lshrrev_b32 v37, 2, v36
    v_and_b32_e64 v36, 3, v36
    v_lshl_add_u32 v36, v37, 6, v36
    v_lshlrev_b32_e64 v36, 8, v36
    v_subrev_u32 v36, 2048, v36
    v_xor_b32_e64 v34, 8, v31
    v_lshl_add_u32 v14, v34, 4, v36
    v_add_u32 v28, v35, v36
    v_add_u32 v36, 12, v33
    v_lshrrev_b32 v37, 2, v36
    v_and_b32 v36, 3, v36
    v_lshl_add_u32 v36, v37, 6, v36
    v_lshlrev_b32_e64 v36, 8, v36
    v_subrev_u32 v36, 3072, v36
    v_xor_b32_e64 v34, 12, v31
    v_lshl_add_u32 v15, v34, 4, v36
    v_add_u32_e64 v29, v35, v36
    v_xor_b32 v29, 128, v29
    s_mov_b32 s52, s68
    s_mov_b32 s53, s69
    s_mov_b32 s54, 8388608
    s_mov_b32 s55, 0x20000
    s_lshl_b32 s42, s33, 21
    s_lshl_b32 s39, s35, 8
    s_add_u32 s42, s42, s39
    v_lshlrev_b32 v30, 11, v33
    v_add3_u32 v17, v30, v35, s42
    v_add_u32 v18, 7168, v17
    v_add_u32 v19, 14336, v17
    v_add_u32 v20, 21504, v17
    v_xor_b32 v18, 128, v18
    v_xor_b32 v20, 128, v20
    s_lshl_b32 s40, s34, 2
    s_add_u32 s40, s40, s37
    s_lshl_b32 s42, s32, 4
    s_add_u32 s42, s42, s40
    s_lshl_b32 s42, s42, 5
    s_lshl_b32 s39, s33, 3
    s_add_u32 s42, s42, s39
    s_lshl_b32 s42, s42, 13
    v_lshlrev_b32_e64 v21, 4, v0
    v_add_u32 v21, s42, v21
    s_lshl_b32 s41, s30, 12
    s_add_u32 s41, s41, 33554432
    s_lshl_b32 s39, s40, 5
    s_add_u32 s39, s39, 512
    v_and_b32 v22, 7, v0
    v_lshl_add_u32 v22, v22, 2, s39
    v_lshlrev_b32_e64 v23, 2, v0
    v_add_u32 v23, 896, v23
    v_cmp_lt_u32 vcc, 31, v0
    s_nop 1
    v_cndmask_b32 v22, v22, v23, vcc
    s_bfe_u32 s46, s50, 0x40004
    s_lshl_b32 s47, s46, 19
    s_lshl_b32 s48, s46, 7
    s_add_u32 m0, s44, 16384
    s_nop 0
    buffer_load_dwordx4 v2, s[4:7], s47 offen lds
    buffer_load_dwordx4 v3, s[4:7], s47 offen offset:1024 lds
    buffer_load_dwordx4 v4, s[4:7], s47 offen offset:2048 lds
    buffer_load_dwordx4 v5, s[4:7], s47 offen offset:3072 lds
    s_add_u32 m0, s44, 81920
    s_nop 0
    buffer_load_dwordx4 v6, s[8:11], s48 offen lds
    buffer_load_dwordx4 v7, s[8:11], s48 offen offset:1024 lds
    buffer_load_dwordx4 v8, s[8:11], s48 offen offset:2048 lds
    buffer_load_dwordx4 v9, s[8:11], s48 offen offset:3072 lds
    s_bfe_u32 s46, s50, 0x40008
    s_lshl_b32 s47, s46, 19
    s_lshl_b32 s48, s46, 7
    s_add_u32 m0, s44, 32768
    s_nop 0
    buffer_load_dwordx4 v2, s[4:7], s47 offen lds
    buffer_load_dwordx4 v3, s[4:7], s47 offen offset:1024 lds
    buffer_load_dwordx4 v4, s[4:7], s47 offen offset:2048 lds
    buffer_load_dwordx4 v5, s[4:7], s47 offen offset:3072 lds
    s_add_u32 m0, s44, 98304
    s_nop 0
    buffer_load_dwordx4 v6, s[8:11], s48 offen lds
    buffer_load_dwordx4 v7, s[8:11], s48 offen offset:1024 lds
    buffer_load_dwordx4 v8, s[8:11], s48 offen offset:2048 lds
    buffer_load_dwordx4 v9, s[8:11], s48 offen offset:3072 lds
    s_waitcnt vmcnt(16)
    s_barrier
    s_bfe_u32 s46, s50, 0x4000c
    s_lshl_b32 s47, s46, 19
    s_lshl_b32 s48, s46, 7
    s_add_u32 m0, s44, 49152
    s_nop 0
    buffer_load_dwordx4 v2, s[4:7], s47 offen lds
    buffer_load_dwordx4 v3, s[4:7], s47 offen offset:1024 lds
    buffer_load_dwordx4 v4, s[4:7], s47 offen offset:2048 lds
    buffer_load_dwordx4 v5, s[4:7], s47 offen offset:3072 lds
    s_add_u32 m0, s44, 114688
    s_nop 0
    buffer_load_dwordx4 v6, s[8:11], s48 offen lds
    buffer_load_dwordx4 v7, s[8:11], s48 offen offset:1024 lds
    buffer_load_dwordx4 v8, s[8:11], s48 offen offset:2048 lds
    buffer_load_dwordx4 v9, s[8:11], s48 offen offset:3072 lds
    s_cmp_lg_u32 s37, 0
    s_cbranch_scc1 L_nosw
    s_and_b32 s39, s31, 1
    s_lshl_b32 s39, s39, 21
    s_add_u32 s39, s39, 0x400000
    s_load_dword s90, s[66:67], s39
    s_load_dword s90, s[62:63], 0
    s_load_dword s90, s[64:65], 0
    s_lshl_b32 s39, s33, 21
    s_load_dword s90, s[68:69], s39
    s_load_dword s90, s[70:71], 0
L_nosw:
    s_waitcnt vmcnt(16)
    s_barrier
    s_bfe_u32 s46, s50, 0x40010
    s_lshl_b32 s47, s46, 19
    s_lshl_b32 s48, s46, 7
    s_add_u32 m0, s44, 0
    s_nop 0
    buffer_load_dwordx4 v2, s[4:7], s47 offen lds
    buffer_load_dwordx4 v3, s[4:7], s47 offen offset:1024 lds
    buffer_load_dwordx4 v4, s[4:7], s47 offen offset:2048 lds
    buffer_load_dwordx4 v5, s[4:7], s47 offen offset:3072 lds
    s_add_u32 m0, s44, 65536
    s_nop 0
    buffer_load_dwordx4 v6, s[8:11], s48 offen lds
    buffer_load_dwordx4 v7, s[8:11], s48 offen offset:1024 lds
    buffer_load_dwordx4 v8, s[8:11], s48 offen offset:2048 lds
    buffer_load_dwordx4 v9, s[8:11], s48 offen offset:3072 lds
    s_lshl_b32 s39, s32, 5
    s_add_u32 s39, s39, s31
    s_lshl_b32 s39, s39, 17
    s_lshl_b32 s42, s37, 13
    s_add_u32 s39, s39, s42
    s_add_u32 s39, s39, 16777216
    v_lshlrev_b32 v1, 4, v0
    v_mov_b32 v40, -1
    v_mov_b32 v41, -1
    v_mov_b32 v42, -1
    v_mov_b32 v43, -1
    s_xor_b32 s42, s33, 3
    s_lshl_b32 s42, s42, 15
    s_add_u32 s42, s39, s42
    buffer_store_dwordx4 v[40:43], v1, s[12:15], s42 offen offset:0 sc1
    buffer_store_dwordx4 v[40:43], v1, s[12:15], s42 offen offset:1024 sc1
    s_xor_b32 s42, s33, 2
    s_lshl_b32 s42, s42, 15
    s_add_u32 s42, s39, s42
    s_add_u32 s42, s42, 2048
    buffer_store_dwordx4 v[40:43], v1, s[12:15], s42 offen offset:0 sc1
    buffer_store_dwordx4 v[40:43], v1, s[12:15], s42 offen offset:1024 sc1
    s_xor_b32 s42, s33, 1
    s_lshl_b32 s42, s42, 15
    s_add_u32 s42, s39, s42
    s_add_u32 s42, s42, 4096
    buffer_store_dwordx4 v[40:43], v1, s[12:15], s42 offen offset:0 sc1
    buffer_store_dwordx4 v[40:43], v1, s[12:15], s42 offen offset:1024 sc1
    s_waitcnt vmcnt(22)
    s_barrier
    s_bfe_u32 s46, s50, 0x40014
    s_lshl_b32 s47, s46, 19
    s_lshl_b32 s48, s46, 7
    s_add_u32 m0, s44, 16384
    s_nop 0
    buffer_load_dwordx4 v2, s[4:7], s47 offen lds
    buffer_load_dwordx4 v3, s[4:7], s47 offen offset:1024 lds
    buffer_load_dwordx4 v4, s[4:7], s47 offen offset:2048 lds
    buffer_load_dwordx4 v5, s[4:7], s47 offen offset:3072 lds
    s_add_u32 m0, s44, 81920
    s_nop 0
    buffer_load_dwordx4 v6, s[8:11], s48 offen lds
    buffer_load_dwordx4 v7, s[8:11], s48 offen offset:1024 lds
    buffer_load_dwordx4 v8, s[8:11], s48 offen offset:2048 lds
    buffer_load_dwordx4 v9, s[8:11], s48 offen offset:3072 lds
    s_waitcnt vmcnt(22)
    s_barrier
    s_bfe_u32 s46, s50, 0x40018
    s_lshl_b32 s47, s46, 19
    s_lshl_b32 s48, s46, 7
    s_add_u32 m0, s44, 32768
    s_nop 0
    buffer_load_dwordx4 v2, s[4:7], s47 offen lds
    buffer_load_dwordx4 v3, s[4:7], s47 offen offset:1024 lds
    buffer_load_dwordx4 v4, s[4:7], s47 offen offset:2048 lds
    buffer_load_dwordx4 v5, s[4:7], s47 offen offset:3072 lds
    s_add_u32 m0, s44, 98304
    s_nop 0
    buffer_load_dwordx4 v6, s[8:11], s48 offen lds
    buffer_load_dwordx4 v7, s[8:11], s48 offen offset:1024 lds
    buffer_load_dwordx4 v8, s[8:11], s48 offen offset:2048 lds
    buffer_load_dwordx4 v9, s[8:11], s48 offen offset:3072 lds
    s_waitcnt vmcnt(8)
    s_barrier
    s_bfe_u32 s46, s50, 0x4001c
    s_lshl_b32 s47, s46, 19
    s_lshl_b32 s48, s46, 7
    s_add_u32 m0, s44, 49152
    s_nop 0
    buffer_load_dwordx4 v2, s[4:7], s47 offen lds
    buffer_load_dwordx4 v3, s[4:7], s47 offen offset:1024 lds
    buffer_load_dwordx4 v4, s[4:7], s47 offen offset:2048 lds
    buffer_load_dwordx4 v5, s[4:7], s47 offen offset:3072 lds
    s_add_u32 m0, s44, 114688
    s_nop 0
    buffer_load_dwordx4 v6, s[8:11], s48 offen lds
    buffer_load_dwordx4 v7, s[8:11], s48 offen offset:1024 lds
    buffer_load_dwordx4 v8, s[8:11], s48 offen offset:2048 lds
    buffer_load_dwordx4 v9, s[8:11], s48 offen offset:3072 lds
    s_waitcnt vmcnt(16)
    s_barrier
    s_bfe_u32 s46, s51, 0x40000
    s_lshl_b32 s47, s46, 19
    s_lshl_b32 s48, s46, 7
    s_add_u32 m0, s44, 0
    s_nop 0
    buffer_load_dwordx4 v2, s[4:7], s47 offen lds
    buffer_load_dwordx4 v3, s[4:7], s47 offen offset:1024 lds
    buffer_load_dwordx4 v4, s[4:7], s47 offen offset:2048 lds
    buffer_load_dwordx4 v5, s[4:7], s47 offen offset:3072 lds
    s_add_u32 m0, s44, 65536
    s_nop 0
    buffer_load_dwordx4 v6, s[8:11], s48 offen lds
    buffer_load_dwordx4 v7, s[8:11], s48 offen offset:1024 lds
    buffer_load_dwordx4 v8, s[8:11], s48 offen offset:2048 lds
    buffer_load_dwordx4 v9, s[8:11], s48 offen offset:3072 lds
    s_waitcnt vmcnt(16)
    s_barrier
    s_bfe_u32 s46, s51, 0x40004
    s_lshl_b32 s47, s46, 19
    s_lshl_b32 s48, s46, 7
    s_add_u32 m0, s44, 16384
    s_nop 0
    buffer_load_dwordx4 v2, s[4:7], s47 offen lds
    buffer_load_dwordx4 v3, s[4:7], s47 offen offset:1024 lds
    buffer_load_dwordx4 v4, s[4:7], s47 offen offset:2048 lds
    buffer_load_dwordx4 v5, s[4:7], s47 offen offset:3072 lds
    s_add_u32 m0, s44, 81920
    s_nop 0
    buffer_load_dwordx4 v6, s[8:11], s48 offen lds
    buffer_load_dwordx4 v7, s[8:11], s48 offen offset:1024 lds
    buffer_load_dwordx4 v8, s[8:11], s48 offen offset:2048 lds
    buffer_load_dwordx4 v9, s[8:11], s48 offen offset:3072 lds
    s_waitcnt vmcnt(16)
    s_barrier
    s_bfe_u32 s46, s51, 0x40008
    s_lshl_b32 s47, s46, 19
    s_lshl_b32 s48, s46, 7
    s_add_u32 m0, s44, 32768
    s_nop 0
    buffer_load_dwordx4 v2, s[4:7], s47 offen lds
    buffer_load_dwordx4 v3, s[4:7], s47 offen offset:1024 lds
    buffer_load_dwordx4 v4, s[4:7], s47 offen offset:2048 lds
    buffer_load_dwordx4 v5, s[4:7], s47 offen offset:3072 lds
    s_add_u32 m0, s44, 98304
    s_nop 0
    buffer_load_dwordx4 v6, s[8:11], s48 offen lds
    buffer_load_dwordx4 v7, s[8:11], s48 offen offset:1024 lds
    buffer_load_dwordx4 v8, s[8:11], s48 offen offset:2048 lds
    buffer_load_dwordx4 v9, s[8:11], s48 offen offset:3072 lds
    s_waitcnt vmcnt(16)
    s_barrier
    s_bfe_u32 s46, s51, 0x4000c
    s_lshl_b32 s47, s46, 19
    s_lshl_b32 s48, s46, 7
    s_add_u32 m0, s44, 49152
    s_nop 0
    buffer_load_dwordx4 v2, s[4:7], s47 offen lds
    buffer_load_dwordx4 v3, s[4:7], s47 offen offset:1024 lds
    buffer_load_dwordx4 v4, s[4:7], s47 offen offset:2048 lds
    buffer_load_dwordx4 v5, s[4:7], s47 offen offset:3072 lds
    s_add_u32 m0, s44, 114688
    s_nop 0
    buffer_load_dwordx4 v6, s[8:11], s48 offen lds
    buffer_load_dwordx4 v7, s[8:11], s48 offen offset:1024 lds
    buffer_load_dwordx4 v8, s[8:11], s48 offen offset:2048 lds
    buffer_load_dwordx4 v9, s[8:11], s48 offen offset:3072 lds
    s_waitcnt vmcnt(16)
    s_barrier
    s_bfe_u32 s46, s51, 0x40010
    s_lshl_b32 s47, s46, 19
    s_lshl_b32 s48, s46, 7
    s_add_u32 m0, s44, 0
    s_nop 0
    buffer_load_dwordx4 v2, s[4:7], s47 offen lds
    buffer_load_dwordx4 v3, s[4:7], s47 offen offset:1024 lds
    buffer_load_dwordx4 v4, s[4:7], s47 offen offset:2048 lds
    buffer_load_dwordx4 v5, s[4:7], s47 offen offset:3072 lds
    s_add_u32 m0, s44, 65536
    s_nop 0
    buffer_load_dwordx4 v6, s[8:11], s48 offen lds
    buffer_load_dwordx4 v7, s[8:11], s48 offen offset:1024 lds
    buffer_load_dwordx4 v8, s[8:11], s48 offen offset:2048 lds
    buffer_load_dwordx4 v9, s[8:11], s48 offen offset:3072 lds
    s_waitcnt vmcnt(16)
    s_barrier
    s_bfe_u32 s46, s51, 0x40014
    s_lshl_b32 s47, s46, 19
    s_lshl_b32 s48, s46, 7
    s_add_u32 m0, s44, 16384
    s_nop 0
    buffer_load_dwordx4 v2, s[4:7], s47 offen lds
    buffer_load_dwordx4 v3, s[4:7], s47 offen offset:1024 lds
    buffer_load_dwordx4 v4, s[4:7], s47 offen offset:2048 lds
    buffer_load_dwordx4 v5, s[4:7], s47 offen offset:3072 lds
    s_add_u32 m0, s44, 81920
    s_nop 0
    buffer_load_dwordx4 v6, s[8:11], s48 offen lds
    buffer_load_dwordx4 v7, s[8:11], s48 offen offset:1024 lds
    buffer_load_dwordx4 v8, s[8:11], s48 offen offset:2048 lds
    buffer_load_dwordx4 v9, s[8:11], s48 offen offset:3072 lds
    s_waitcnt vmcnt(16)
    s_barrier
    s_bfe_u32 s46, s51, 0x40018
    s_lshl_b32 s47, s46, 19
    s_lshl_b32 s48, s46, 7
    s_add_u32 m0, s44, 32768
    s_nop 0
    buffer_load_dwordx4 v2, s[4:7], s47 offen lds
    buffer_load_dwordx4 v3, s[4:7], s47 offen offset:1024 lds
    buffer_load_dwordx4 v4, s[4:7], s47 offen offset:2048 lds
    buffer_load_dwordx4 v5, s[4:7], s47 offen offset:3072 lds
    s_add_u32 m0, s44, 98304
    s_nop 0
    buffer_load_dwordx4 v6, s[8:11], s48 offen lds
    buffer_load_dwordx4 v7, s[8:11], s48 offen offset:1024 lds
    buffer_load_dwordx4 v8, s[8:11], s48 offen offset:2048 lds
    buffer_load_dwordx4 v9, s[8:11], s48 offen offset:3072 lds
    s_waitcnt vmcnt(16)
    s_barrier
    s_bfe_u32 s46, s51, 0x4001c
    s_lshl_b32 s47, s46, 19
    s_lshl_b32 s48, s46, 7
    s_add_u32 m0, s44, 49152
    s_nop 0
    buffer_load_dwordx4 v2, s[4:7], s47 offen lds
    buffer_load_dwordx4 v3, s[4:7], s47 offen offset:1024 lds
    buffer_load_dwordx4 v4, s[4:7], s47 offen offset:2048 lds
    buffer_load_dwordx4 v5, s[4:7], s47 offen offset:3072 lds
    s_add_u32 m0, s44, 114688
    s_nop 0
    buffer_load_dwordx4 v6, s[8:11], s48 offen lds
    buffer_load_dwordx4 v7, s[8:11], s48 offen offset:1024 lds
    buffer_load_dwordx4 v8, s[8:11], s48 offen offset:2048 lds
    buffer_load_dwordx4 v9, s[8:11], s48 offen offset:3072 lds
    s_waitcnt vmcnt(16)
    s_barrier
    s_xor_b32 s47, s45, 0
    s_add_u32 m0, s44, 0
    s_nop 0
    buffer_load_dwordx4 v12, s[20:23], s47 offen nt lds
    buffer_load_dwordx4 v13, s[20:23], s47 offen offset:1024 nt lds
    buffer_load_dwordx4 v14, s[20:23], s47 offen offset:2048 nt lds
    buffer_load_dwordx4 v15, s[20:23], s47 offen offset:3072 nt lds
    s_waitcnt vmcnt(12)
    s_barrier
    s_waitcnt vmcnt(4)
    s_barrier
    s_xor_b32 s47, s45, 1024
    s_add_u32 m0, s44, 16384
    s_nop 0
    buffer_load_dwordx4 v12, s[20:23], s47 offen nt lds
    buffer_load_dwordx4 v13, s[20:23], s47 offen offset:1024 nt lds
    buffer_load_dwordx4 v14, s[20:23], s47 offen offset:2048 nt lds
    buffer_load_dwordx4 v15, s[20:23], s47 offen offset:3072 nt lds
    s_xor_b32 s48, s45, 0
    s_add_u32 m0, s44, 81920
    s_nop 0
    buffer_load_dwordx4 v26, s[24:27], s48 offen nt lds
    buffer_load_dwordx4 v27, s[24:27], s48 offen offset:1024 nt lds
    buffer_load_dwordx4 v28, s[24:27], s48 offen offset:2048 nt lds
    buffer_load_dwordx4 v29, s[24:27], s48 offen offset:3072 nt lds
    s_waitcnt vmcnt(8)
    s_barrier
    s_xor_b32 s47, s45, 2048
    s_add_u32 m0, s44, 32768
    s_nop 0
    buffer_load_dwordx4 v12, s[20:23], s47 offen nt lds
    buffer_load_dwordx4 v13, s[20:23], s47 offen offset:1024 nt lds
    buffer_load_dwordx4 v14, s[20:23], s47 offen offset:2048 nt lds
    buffer_load_dwordx4 v15, s[20:23], s47 offen offset:3072 nt lds
    s_xor_b32 s48, s45, 1024
    s_add_u32 m0, s44, 98304
    s_nop 0
    buffer_load_dwordx4 v26, s[24:27], s48 offen nt lds
    buffer_load_dwordx4 v27, s[24:27], s48 offen offset:1024 nt lds
    buffer_load_dwordx4 v28, s[24:27], s48 offen offset:2048 nt lds
    buffer_load_dwordx4 v29, s[24:27], s48 offen offset:3072 nt lds
    s_waitcnt vmcnt(8)
    s_barrier
    s_xor_b32 s47, s45, 3072
    s_add_u32 m0, s44, 49152
    s_nop 0
    buffer_load_dwordx4 v12, s[20:23], s47 offen nt lds
    buffer_load_dwordx4 v13, s[20:23], s47 offen offset:1024 nt lds
    buffer_load_dwordx4 v14, s[20:23], s47 offen offset:2048 nt lds
    buffer_load_dwordx4 v15, s[20:23], s47 offen offset:3072 nt lds
    s_xor_b32 s48, s45, 2048
    s_add_u32 m0, s44, 114688
    s_nop 0
    buffer_load_dwordx4 v26, s[24:27], s48 offen nt lds
    buffer_load_dwordx4 v27, s[24:27], s48 offen offset:1024 nt lds
    buffer_load_dwordx4 v28, s[24:27], s48 offen offset:2048 nt lds
    buffer_load_dwordx4 v29, s[24:27], s48 offen offset:3072 nt lds
    s_waitcnt vmcnt(4)
    s_barrier
    s_xor_b32 s47, s45, 4096
    s_add_u32 m0, s44, 0
    s_nop 0
    buffer_load_dwordx4 v12, s[20:23], s47 offen nt lds
    buffer_load_dwordx4 v13, s[20:23], s47 offen offset:1024 nt lds
    buffer_load_dwordx4 v14, s[20:23], s47 offen offset:2048 nt lds
    buffer_load_dwordx4 v15, s[20:23], s47 offen offset:3072 nt lds
    s_xor_b32 s48, s45, 3072
    s_add_u32 m0, s44, 65536
    s_nop 0
    buffer_load_dwordx4 v26, s[24:27], s48 offen nt lds
    buffer_load_dwordx4 v27, s[24:27], s48 offen offset:1024 nt lds
    buffer_load_dwordx4 v28, s[24:27], s48 offen offset:2048 nt lds
    buffer_load_dwordx4 v29, s[24:27], s48 offen offset:3072 nt lds
    s_waitcnt vmcnt(4)
    s_barrier
    s_xor_b32 s47, s45, 5120
    s_add_u32 m0, s44, 16384
    s_nop 0
    buffer_load_dwordx4 v12, s[20:23], s47 offen nt lds
    buffer_load_dwordx4 v13, s[20:23], s47 offen offset:1024 nt lds
    buffer_load_dwordx4 v14, s[20:23], s47 offen offset:2048 nt lds
    buffer_load_dwordx4 v15, s[20:23], s47 offen offset:3072 nt lds
    s_xor_b32 s48, s45, 4096
    s_add_u32 m0, s44, 81920
    s_nop 0
    buffer_load_dwordx4 v26, s[24:27], s48 offen nt lds
    buffer_load_dwordx4 v27, s[24:27], s48 offen offset:1024 nt lds
    buffer_load_dwordx4 v28, s[24:27], s48 offen offset:2048 nt lds
    buffer_load_dwordx4 v29, s[24:27], s48 offen offset:3072 nt lds
    s_waitcnt vmcnt(0)
    s_barrier
    s_xor_b32 s47, s45, 6144
    s_add_u32 m0, s44, 32768
    s_nop 0
    buffer_load_dwordx4 v12, s[20:23], s47 offen nt lds
    buffer_load_dwordx4 v13, s[20:23], s47 offen offset:1024 nt lds
    buffer_load_dwordx4 v14, s[20:23], s47 offen offset:2048 nt lds
    buffer_load_dwordx4 v15, s[20:23], s47 offen offset:3072 nt lds
    s_xor_b32 s48, s45, 5120
    s_add_u32 m0, s44, 98304
    s_nop 0
    buffer_load_dwordx4 v26, s[24:27], s48 offen nt lds
    buffer_load_dwordx4 v27, s[24:27], s48 offen offset:1024 nt lds
    buffer_load_dwordx4 v28, s[24:27], s48 offen offset:2048 nt lds
    buffer_load_dwordx4 v29, s[24:27], s48 offen offset:3072 nt lds
    s_waitcnt vmcnt(4)
    s_barrier
    s_xor_b32 s47, s45, 7168
    s_add_u32 m0, s44, 49152
    s_nop 0
    buffer_load_dwordx4 v12, s[20:23], s47 offen nt lds
    buffer_load_dwordx4 v13, s[20:23], s47 offen offset:1024 nt lds
    buffer_load_dwordx4 v14, s[20:23], s47 offen offset:2048 nt lds
    buffer_load_dwordx4 v15, s[20:23], s47 offen offset:3072 nt lds
    s_xor_b32 s48, s45, 6144
    s_add_u32 m0, s44, 114688
    s_nop 0
    buffer_load_dwordx4 v26, s[24:27], s48 offen nt lds
    buffer_load_dwordx4 v27, s[24:27], s48 offen offset:1024 nt lds
    buffer_load_dwordx4 v28, s[24:27], s48 offen offset:2048 nt lds
    buffer_load_dwordx4 v29, s[24:27], s48 offen offset:3072 nt lds
    s_bitcmp1_b32 s59, 0
    s_mov_b32 s42, 0xc5832410
    s_cselect_b32 s42, 0x69435201, s42
    s_mov_b32 s43, 0xa5463102
    s_cselect_b32 s43, 0x65742130, s43
    s_bitcmp1_b32 s59, 1
    s_cselect_b32 s50, s43, s42
    s_bitcmp1_b32 s59, 0
    s_mov_b32 s42, 0xfedba976
    s_cselect_b32 s42, 0xfecba87d, s42
    s_mov_b32 s43, 0xfdcb98e7
    s_cselect_b32 s43, 0xedca9f8b, s43
    s_bitcmp1_b32 s59, 1
    s_cselect_b32 s51, s43, s42
    s_waitcnt vmcnt(4)
    s_barrier
    s_xor_b32 s47, s45, 8192
    s_add_u32 m0, s44, 0
    s_nop 0
    buffer_load_dwordx4 v12, s[20:23], s47 offen nt lds
    buffer_load_dwordx4 v13, s[20:23], s47 offen offset:1024 nt lds
    buffer_load_dwordx4 v14, s[20:23], s47 offen offset:2048 nt lds
    buffer_load_dwordx4 v15, s[20:23], s47 offen offset:3072 nt lds
    s_xor_b32 s48, s45, 7168
    s_add_u32 m0, s44, 65536
    s_nop 0
    buffer_load_dwordx4 v26, s[24:27], s48 offen nt lds
    buffer_load_dwordx4 v27, s[24:27], s48 offen offset:1024 nt lds
    buffer_load_dwordx4 v28, s[24:27], s48 offen offset:2048 nt lds
    buffer_load_dwordx4 v29, s[24:27], s48 offen offset:3072 nt lds
    s_waitcnt vmcnt(4)
    s_barrier
    s_xor_b32 s47, s45, 9216
    s_add_u32 m0, s44, 16384
    s_nop 0
    buffer_load_dwordx4 v12, s[20:23], s47 offen nt lds
    buffer_load_dwordx4 v13, s[20:23], s47 offen offset:1024 nt lds
    buffer_load_dwordx4 v14, s[20:23], s47 offen offset:2048 nt lds
    buffer_load_dwordx4 v15, s[20:23], s47 offen offset:3072 nt lds
    s_xor_b32 s48, s45, 8192
    s_add_u32 m0, s44, 81920
    s_nop 0
    buffer_load_dwordx4 v26, s[24:27], s48 offen nt lds
    buffer_load_dwordx4 v27, s[24:27], s48 offen offset:1024 nt lds
    buffer_load_dwordx4 v28, s[24:27], s48 offen offset:2048 nt lds
    buffer_load_dwordx4 v29, s[24:27], s48 offen offset:3072 nt lds
    s_waitcnt vmcnt(4)
    s_barrier
    s_xor_b32 s47, s45, 10240
    s_add_u32 m0, s44, 32768
    s_nop 0
    buffer_load_dwordx4 v12, s[20:23], s47 offen nt lds
    buffer_load_dwordx4 v13, s[20:23], s47 offen offset:1024 nt lds
    buffer_load_dwordx4 v14, s[20:23], s47 offen offset:2048 nt lds
    buffer_load_dwordx4 v15, s[20:23], s47 offen offset:3072 nt lds
    s_xor_b32 s48, s45, 9216
    s_add_u32 m0, s44, 98304
    s_nop 0
    buffer_load_dwordx4 v26, s[24:27], s48 offen nt lds
    buffer_load_dwordx4 v27, s[24:27], s48 offen offset:1024 nt lds
    buffer_load_dwordx4 v28, s[24:27], s48 offen offset:2048 nt lds
    buffer_load_dwordx4 v29, s[24:27], s48 offen offset:3072 nt lds
    s_waitcnt vmcnt(4)
    s_barrier
    s_xor_b32 s47, s45, 11264
    s_add_u32 m0, s44, 49152
    s_nop 0
    buffer_load_dwordx4 v12, s[20:23], s47 offen nt lds
    buffer_load_dwordx4 v13, s[20:23], s47 offen offset:1024 nt lds
    buffer_load_dwordx4 v14, s[20:23], s47 offen offset:2048 nt lds
    buffer_load_dwordx4 v15, s[20:23], s47 offen offset:3072 nt lds
    s_xor_b32 s48, s45, 10240
    s_add_u32 m0, s44, 114688
    s_nop 0
    buffer_load_dwordx4 v26, s[24:27], s48 offen nt lds
    buffer_load_dwordx4 v27, s[24:27], s48 offen offset:1024 nt lds
    buffer_load_dwordx4 v28, s[24:27], s48 offen offset:2048 nt lds
    buffer_load_dwordx4 v29, s[24:27], s48 offen offset:3072 nt lds
    s_waitcnt vmcnt(8)
    s_barrier
    s_xor_b32 s47, s45, 12288
    s_add_u32 m0, s44, 0
    s_nop 0
    buffer_load_dwordx4 v12, s[20:23], s47 offen nt lds
    buffer_load_dwordx4 v13, s[20:23], s47 offen offset:1024 nt lds
    buffer_load_dwordx4 v14, s[20:23], s47 offen offset:2048 nt lds
    buffer_load_dwordx4 v15, s[20:23], s47 offen offset:3072 nt lds
    s_xor_b32 s48, s45, 11264
    s_add_u32 m0, s44, 65536
    s_nop 0
    buffer_load_dwordx4 v26, s[24:27], s48 offen nt lds
    buffer_load_dwordx4 v27, s[24:27], s48 offen offset:1024 nt lds
    buffer_load_dwordx4 v28, s[24:27], s48 offen offset:2048 nt lds
    buffer_load_dwordx4 v29, s[24:27], s48 offen offset:3072 nt lds
    s_waitcnt vmcnt(8)
    s_barrier
    s_xor_b32 s47, s45, 13312
    s_add_u32 m0, s44, 16384
    s_nop 0
    buffer_load_dwordx4 v12, s[20:23], s47 offen nt lds
    buffer_load_dwordx4 v13, s[20:23], s47 offen offset:1024 nt lds
    buffer_load_dwordx4 v14, s[20:23], s47 offen offset:2048 nt lds
    buffer_load_dwordx4 v15, s[20:23], s47 offen offset:3072 nt lds
    s_xor_b32 s48, s45, 12288
    s_add_u32 m0, s44, 81920
    s_nop 0
    buffer_load_dwordx4 v26, s[24:27], s48 offen nt lds
    buffer_load_dwordx4 v27, s[24:27], s48 offen offset:1024 nt lds
    buffer_load_dwordx4 v28, s[24:27], s48 offen offset:2048 nt lds
    buffer_load_dwordx4 v29, s[24:27], s48 offen offset:3072 nt lds
    s_waitcnt vmcnt(8)
    s_barrier
    s_xor_b32 s47, s45, 14336
    s_add_u32 m0, s44, 32768
    s_nop 0
    buffer_load_dwordx4 v12, s[20:23], s47 offen nt lds
    buffer_load_dwordx4 v13, s[20:23], s47 offen offset:1024 nt lds
    buffer_load_dwordx4 v14, s[20:23], s47 offen offset:2048 nt lds
    buffer_load_dwordx4 v15, s[20:23], s47 offen offset:3072 nt lds
    s_xor_b32 s48, s45, 13312
    s_add_u32 m0, s44, 98304
    s_nop 0
    buffer_load_dwordx4 v26, s[24:27], s48 offen nt lds
    buffer_load_dwordx4 v27, s[24:27], s48 offen offset:1024 nt lds
    buffer_load_dwordx4 v28, s[24:27], s48 offen offset:2048 nt lds
    buffer_load_dwordx4 v29, s[24:27], s48 offen offset:3072 nt lds
    s_waitcnt vmcnt(8)
    s_barrier
    s_xor_b32 s47, s45, 15360
    s_add_u32 m0, s44, 49152
    s_nop 0
    buffer_load_dwordx4 v12, s[20:23], s47 offen nt lds
    buffer_load_dwordx4 v13, s[20:23], s47 offen offset:1024 nt lds
    buffer_load_dwordx4 v14, s[20:23], s47 offen offset:2048 nt lds
    buffer_load_dwordx4 v15, s[20:23], s47 offen offset:3072 nt lds
    s_xor_b32 s48, s45, 14336
    s_add_u32 m0, s44, 114688
    s_nop 0
    buffer_load_dwordx4 v26, s[24:27], s48 offen nt lds
    buffer_load_dwordx4 v27, s[24:27], s48 offen offset:1024 nt lds
    buffer_load_dwordx4 v28, s[24:27], s48 offen offset:2048 nt lds
    buffer_load_dwordx4 v29, s[24:27], s48 offen offset:3072 nt lds
    s_waitcnt vmcnt(8)
    s_barrier
    s_xor_b32 s48, s45, 15360
    s_add_u32 m0, s44, 65536
    s_nop 0
    buffer_load_dwordx4 v26, s[24:27], s48 offen nt lds
    buffer_load_dwordx4 v27, s[24:27], s48 offen offset:1024 nt lds
    buffer_load_dwordx4 v28, s[24:27], s48 offen offset:2048 nt lds
    buffer_load_dwordx4 v29, s[24:27], s48 offen offset:3072 nt lds
    s_bfe_u32 s46, s50, 0x40000
    s_lshl_b32 s47, s46, 17
    s_add_u32 m0, s44, 131072
    s_nop 0
    buffer_load_dwordx4 v17, s[52:55], s47 offen lds
    buffer_load_dwordx4 v18, s[52:55], s47 offen offset:1024 lds
    buffer_load_dwordx4 v19, s[52:55], s47 offen offset:2048 lds
    buffer_load_dwordx4 v20, s[52:55], s47 offen offset:3072 lds
    s_waitcnt vmcnt(8)
    s_barrier
    s_bfe_u32 s46, s50, 0x40004
    s_lshl_b32 s47, s46, 17
    s_add_u32 m0, s44, 147456
    s_nop 0
    buffer_load_dwordx4 v17, s[52:55], s47 offen lds
    buffer_load_dwordx4 v18, s[52:55], s47 offen offset:1024 lds
    buffer_load_dwordx4 v19, s[52:55], s47 offen offset:2048 lds
    buffer_load_dwordx4 v20, s[52:55], s47 offen offset:3072 lds
    s_bfe_u32 s46, s50, 0x40008
    s_lshl_b32 s47, s46, 17
    s_add_u32 m0, s44, 0
    s_nop 0
    buffer_load_dwordx4 v17, s[52:55], s47 offen lds
    buffer_load_dwordx4 v18, s[52:55], s47 offen offset:1024 lds
    buffer_load_dwordx4 v19, s[52:55], s47 offen offset:2048 lds
    buffer_load_dwordx4 v20, s[52:55], s47 offen offset:3072 lds
    s_waitcnt vmcnt(12)
    s_barrier
    s_bfe_u32 s46, s50, 0x4000c
    s_lshl_b32 s47, s46, 17
    s_add_u32 m0, s44, 16384
    s_nop 0
    buffer_load_dwordx4 v17, s[52:55], s47 offen lds
    buffer_load_dwordx4 v18, s[52:55], s47 offen offset:1024 lds
    buffer_load_dwordx4 v19, s[52:55], s47 offen offset:2048 lds
    buffer_load_dwordx4 v20, s[52:55], s47 offen offset:3072 lds
    s_bfe_u32 s46, s50, 0x40010
    s_lshl_b32 s47, s46, 17
    s_add_u32 m0, s44, 81920
    s_nop 0
    buffer_load_dwordx4 v17, s[52:55], s47 offen lds
    buffer_load_dwordx4 v18, s[52:55], s47 offen offset:1024 lds
    buffer_load_dwordx4 v19, s[52:55], s47 offen offset:2048 lds
    buffer_load_dwordx4 v20, s[52:55], s47 offen offset:3072 lds
    s_barrier
    s_mov_b32 s56, 0
L_opoll:
    buffer_load_dword v23, v22, s[12:15], s41 offen sc1
    s_add_u32 s56, s56, 1
    s_waitcnt vmcnt(0)
    v_cmp_eq_u32 vcc, 1, v23
    s_cmp_ge_u32 s56, 262144
    s_cbranch_scc1 L_opoll_go
    s_cmp_eq_u32 vcc_lo, -1
    s_cbranch_scc0 L_opoll
L_opoll_go:
    s_cmp_eq_u32 vcc_hi, -1
    s_cbranch_scc1 L_oacq
    buffer_inv sc1
    s_waitcnt vmcnt(0)
L_oacq:
    s_bfe_u32 s46, s50, 0x40000
    s_lshl_b32 s48, s46, 12
    s_add_u32 m0, s44, 49152
    s_nop 0
    buffer_load_dwordx4 v21, s[12:15], s48 offen sc1 lds
    buffer_load_dwordx4 v21, s[12:15], s48 offen offset:1024 sc1 lds
    buffer_load_dwordx4 v21, s[12:15], s48 offen offset:2048 sc1 lds
    buffer_load_dwordx4 v21, s[12:15], s48 offen offset:3072 sc1 lds
    s_bfe_u32 s46, s50, 0x40004
    s_lshl_b32 s48, s46, 12
    s_add_u32 m0, s44, 114688
    s_nop 0
    buffer_load_dwordx4 v21, s[12:15], s48 offen sc1 lds
    buffer_load_dwordx4 v21, s[12:15], s48 offen offset:1024 sc1 lds
    buffer_load_dwordx4 v21, s[12:15], s48 offen offset:2048 sc1 lds
    buffer_load_dwordx4 v21, s[12:15], s48 offen offset:3072 sc1 lds
    s_bfe_u32 s46, s50, 0x40008
    s_lshl_b32 s48, s46, 12
    s_add_u32 m0, s44, 65536
    s_nop 0
    buffer_load_dwordx4 v21, s[12:15], s48 offen sc1 lds
    buffer_load_dwordx4 v21, s[12:15], s48 offen offset:1024 sc1 lds
    buffer_load_dwordx4 v21, s[12:15], s48 offen offset:2048 sc1 lds
    buffer_load_dwordx4 v21, s[12:15], s48 offen offset:3072 sc1 lds
    s_waitcnt vmcnt(8)
    s_barrier
    s_bfe_u32 s46, s50, 0x40014
    s_lshl_b32 s47, s46, 17
    s_add_u32 m0, s44, 32768
    s_nop 0
    buffer_load_dwordx4 v17, s[52:55], s47 offen lds
    buffer_load_dwordx4 v18, s[52:55], s47 offen offset:1024 lds
    buffer_load_dwordx4 v19, s[52:55], s47 offen offset:2048 lds
    buffer_load_dwordx4 v20, s[52:55], s47 offen offset:3072 lds
    s_bfe_u32 s46, s50, 0x40018
    s_lshl_b32 s47, s46, 17
    s_add_u32 m0, s44, 98304
    s_nop 0
    buffer_load_dwordx4 v17, s[52:55], s47 offen lds
    buffer_load_dwordx4 v18, s[52:55], s47 offen offset:1024 lds
    buffer_load_dwordx4 v19, s[52:55], s47 offen offset:2048 lds
    buffer_load_dwordx4 v20, s[52:55], s47 offen offset:3072 lds
    s_waitcnt vmcnt(12)
    s_barrier
    s_bfe_u32 s46, s50, 0x4000c
    s_lshl_b32 s48, s46, 12
    s_add_u32 m0, s44, 49152
    s_nop 0
    buffer_load_dwordx4 v21, s[12:15], s48 offen sc1 lds
    buffer_load_dwordx4 v21, s[12:15], s48 offen offset:1024 sc1 lds
    buffer_load_dwordx4 v21, s[12:15], s48 offen offset:2048 sc1 lds
    buffer_load_dwordx4 v21, s[12:15], s48 offen offset:3072 sc1 lds
    s_bfe_u32 s46, s50, 0x40010
    s_lshl_b32 s48, s46, 12
    s_add_u32 m0, s44, 131072
    s_nop 0
    buffer_load_dwordx4 v21, s[12:15], s48 offen sc1 lds
    buffer_load_dwordx4 v21, s[12:15], s48 offen offset:1024 sc1 lds
    buffer_load_dwordx4 v21, s[12:15], s48 offen offset:2048 sc1 lds
    buffer_load_dwordx4 v21, s[12:15], s48 offen offset:3072 sc1 lds
    s_waitcnt vmcnt(16)
    s_barrier
    s_bfe_u32 s46, s50, 0x40014
    s_lshl_b32 s48, s46, 12
    s_add_u32 m0, s44, 114688
    s_nop 0
    buffer_load_dwordx4 v21, s[12:15], s48 offen sc1 lds
    buffer_load_dwordx4 v21, s[12:15], s48 offen offset:1024 sc1 lds
    buffer_load_dwordx4 v21, s[12:15], s48 offen offset:2048 sc1 lds
    buffer_load_dwordx4 v21, s[12:15], s48 offen offset:3072 sc1 lds
    s_bfe_u32 s46, s50, 0x4001c
    s_lshl_b32 s47, s46, 17
    s_add_u32 m0, s44, 147456
    s_nop 0
    buffer_load_dwordx4 v17, s[52:55], s47 offen lds
    buffer_load_dwordx4 v18, s[52:55], s47 offen offset:1024 lds
    buffer_load_dwordx4 v19, s[52:55], s47 offen offset:2048 lds
    buffer_load_dwordx4 v20, s[52:55], s47 offen offset:3072 lds
    s_waitcnt vmcnt(12)
    s_barrier
    s_bfe_u32 s46, s50, 0x40018
    s_lshl_b32 s48, s46, 12
    s_add_u32 m0, s44, 65536
    s_nop 0
    buffer_load_dwordx4 v21, s[12:15], s48 offen sc1 lds
    buffer_load_dwordx4 v21, s[12:15], s48 offen offset:1024 sc1 lds
    buffer_load_dwordx4 v21, s[12:15], s48 offen offset:2048 sc1 lds
    buffer_load_dwordx4 v21, s[12:15], s48 offen offset:3072 sc1 lds
    s_bfe_u32 s46, s51, 0x40000
    s_lshl_b32 s47, s46, 17
    s_add_u32 m0, s44, 0
    s_nop 0
    buffer_load_dwordx4 v17, s[52:55], s47 offen lds
    buffer_load_dwordx4 v18, s[52:55], s47 offen offset:1024 lds
    buffer_load_dwordx4 v19, s[52:55], s47 offen offset:2048 lds
    buffer_load_dwordx4 v20, s[52:55], s47 offen offset:3072 lds
    s_waitcnt vmcnt(16)
    s_barrier
    s_bfe_u32 s46, s50, 0x4001c
    s_lshl_b32 s48, s46, 12
    s_add_u32 m0, s44, 49152
    s_nop 0
    buffer_load_dwordx4 v21, s[12:15], s48 offen sc1 lds
    buffer_load_dwordx4 v21, s[12:15], s48 offen offset:1024 sc1 lds
    buffer_load_dwordx4 v21, s[12:15], s48 offen offset:2048 sc1 lds
    buffer_load_dwordx4 v21, s[12:15], s48 offen offset:3072 sc1 lds
    s_bfe_u32 s46, s51, 0x40004
    s_lshl_b32 s47, s46, 17
    s_add_u32 m0, s44, 16384
    s_nop 0
    buffer_load_dwordx4 v17, s[52:55], s47 offen lds
    buffer_load_dwordx4 v18, s[52:55], s47 offen offset:1024 lds
    buffer_load_dwordx4 v19, s[52:55], s47 offen offset:2048 lds
    buffer_load_dwordx4 v20, s[52:55], s47 offen offset:3072 lds
    s_waitcnt vmcnt(20)
    s_barrier
    s_bfe_u32 s46, s51, 0x40000
    s_lshl_b32 s48, s46, 12
    s_add_u32 m0, s44, 131072
    s_nop 0
    buffer_load_dwordx4 v21, s[12:15], s48 offen sc1 lds
    buffer_load_dwordx4 v21, s[12:15], s48 offen offset:1024 sc1 lds
    buffer_load_dwordx4 v21, s[12:15], s48 offen offset:2048 sc1 lds
    buffer_load_dwordx4 v21, s[12:15], s48 offen offset:3072 sc1 lds
    s_bfe_u32 s46, s51, 0x40008
    s_lshl_b32 s47, s46, 17
    s_add_u32 m0, s44, 81920
    s_nop 0
    buffer_load_dwordx4 v17, s[52:55], s47 offen lds
    buffer_load_dwordx4 v18, s[52:55], s47 offen offset:1024 lds
    buffer_load_dwordx4 v19, s[52:55], s47 offen offset:2048 lds
    buffer_load_dwordx4 v20, s[52:55], s47 offen offset:3072 lds
    s_waitcnt vmcnt(20)
    s_barrier
    s_bfe_u32 s46, s51, 0x40004
    s_lshl_b32 s48, s46, 12
    s_add_u32 m0, s44, 114688
    s_nop 0
    buffer_load_dwordx4 v21, s[12:15], s48 offen sc1 lds
    buffer_load_dwordx4 v21, s[12:15], s48 offen offset:1024 sc1 lds
    buffer_load_dwordx4 v21, s[12:15], s48 offen offset:2048 sc1 lds
    buffer_load_dwordx4 v21, s[12:15], s48 offen offset:3072 sc1 lds
    s_bfe_u32 s46, s51, 0x4000c
    s_lshl_b32 s47, s46, 17
    s_add_u32 m0, s44, 32768
    s_nop 0
    buffer_load_dwordx4 v17, s[52:55], s47 offen lds
    buffer_load_dwordx4 v18, s[52:55], s47 offen offset:1024 lds
    buffer_load_dwordx4 v19, s[52:55], s47 offen offset:2048 lds
    buffer_load_dwordx4 v20, s[52:55], s47 offen offset:3072 lds
    s_waitcnt vmcnt(20)
    s_barrier
    s_bfe_u32 s46, s51, 0x40008
    s_lshl_b32 s48, s46, 12
    s_add_u32 m0, s44, 65536
    s_nop 0
    buffer_load_dwordx4 v21, s[12:15], s48 offen sc1 lds
    buffer_load_dwordx4 v21, s[12:15], s48 offen offset:1024 sc1 lds
    buffer_load_dwordx4 v21, s[12:15], s48 offen offset:2048 sc1 lds
    buffer_load_dwordx4 v21, s[12:15], s48 offen offset:3072 sc1 lds
    s_bfe_u32 s46, s51, 0x40010
    s_lshl_b32 s47, s46, 17
    s_add_u32 m0, s44, 98304
    s_nop 0
    buffer_load_dwordx4 v17, s[52:55], s47 offen lds
    buffer_load_dwordx4 v18, s[52:55], s47 offen offset:1024 lds
    buffer_load_dwordx4 v19, s[52:55], s47 offen offset:2048 lds
    buffer_load_dwordx4 v20, s[52:55], s47 offen offset:3072 lds
    s_waitcnt vmcnt(20)
    s_barrier
    s_bfe_u32 s46, s51, 0x4000c
    s_lshl_b32 s48, s46, 12
    s_add_u32 m0, s44, 49152
    s_nop 0
    buffer_load_dwordx4 v21, s[12:15], s48 offen sc1 lds
    buffer_load_dwordx4 v21, s[12:15], s48 offen offset:1024 sc1 lds
    buffer_load_dwordx4 v21, s[12:15], s48 offen offset:2048 sc1 lds
    buffer_load_dwordx4 v21, s[12:15], s48 offen offset:3072 sc1 lds
    s_bfe_u32 s46, s51, 0x40014
    s_lshl_b32 s47, s46, 17
    s_add_u32 m0, s44, 147456
    s_nop 0
    buffer_load_dwordx4 v17, s[52:55], s47 offen lds
    buffer_load_dwordx4 v18, s[52:55], s47 offen offset:1024 lds
    buffer_load_dwordx4 v19, s[52:55], s47 offen offset:2048 lds
    buffer_load_dwordx4 v20, s[52:55], s47 offen offset:3072 lds
    s_waitcnt vmcnt(20)
    s_barrier
    s_bfe_u32 s46, s51, 0x40010
    s_lshl_b32 s48, s46, 12
    s_add_u32 m0, s44, 131072
    s_nop 0
    buffer_load_dwordx4 v21, s[12:15], s48 offen sc1 lds
    buffer_load_dwordx4 v21, s[12:15], s48 offen offset:1024 sc1 lds
    buffer_load_dwordx4 v21, s[12:15], s48 offen offset:2048 sc1 lds
    buffer_load_dwordx4 v21, s[12:15], s48 offen offset:3072 sc1 lds
    s_bfe_u32 s46, s51, 0x40018
    s_lshl_b32 s47, s46, 17
    s_add_u32 m0, s44, 0
    s_nop 0
    buffer_load_dwordx4 v17, s[52:55], s47 offen lds
    buffer_load_dwordx4 v18, s[52:55], s47 offen offset:1024 lds
    buffer_load_dwordx4 v19, s[52:55], s47 offen offset:2048 lds
    buffer_load_dwordx4 v20, s[52:55], s47 offen offset:3072 lds
    s_waitcnt vmcnt(20)
    s_barrier
    s_bfe_u32 s46, s51, 0x40014
    s_lshl_b32 s48, s46, 12
    s_add_u32 m0, s44, 114688
    s_nop 0
    buffer_load_dwordx4 v21, s[12:15], s48 offen sc1 lds
    buffer_load_dwordx4 v21, s[12:15], s48 offen offset:1024 sc1 lds
    buffer_load_dwordx4 v21, s[12:15], s48 offen offset:2048 sc1 lds
    buffer_load_dwordx4 v21, s[12:15], s48 offen offset:3072 sc1 lds
    s_bfe_u32 s46, s51, 0x4001c
    s_lshl_b32 s47, s46, 17
    s_add_u32 m0, s44, 16384
    s_nop 0
    buffer_load_dwordx4 v17, s[52:55], s47 offen lds
    buffer_load_dwordx4 v18, s[52:55], s47 offen offset:1024 lds
    buffer_load_dwordx4 v19, s[52:55], s47 offen offset:2048 lds
    buffer_load_dwordx4 v20, s[52:55], s47 offen offset:3072 lds
    s_waitcnt vmcnt(20)
    s_barrier
    s_bfe_u32 s46, s51, 0x40018
    s_lshl_b32 s48, s46, 12
    s_add_u32 m0, s44, 65536
    s_nop 0
    buffer_load_dwordx4 v21, s[12:15], s48 offen sc1 lds
    buffer_load_dwordx4 v21, s[12:15], s48 offen offset:1024 sc1 lds
    buffer_load_dwordx4 v21, s[12:15], s48 offen offset:2048 sc1 lds
    buffer_load_dwordx4 v21, s[12:15], s48 offen offset:3072 sc1 lds
    s_bfe_u32 s46, s51, 0x4001c
    s_lshl_b32 s48, s46, 12
    s_add_u32 m0, s44, 81920
    s_nop 0
    buffer_load_dwordx4 v21, s[12:15], s48 offen sc1 lds
    buffer_load_dwordx4 v21, s[12:15], s48 offen offset:1024 sc1 lds
    buffer_load_dwordx4 v21, s[12:15], s48 offen offset:2048 sc1 lds
    buffer_load_dwordx4 v21, s[12:15], s48 offen offset:3072 sc1 lds
    s_waitcnt vmcnt(20)
    s_barrier
    s_waitcnt vmcnt(12)
    s_barrier
    s_waitcnt vmcnt(4)
    s_barrier
    s_waitcnt vmcnt(0)
    s_barrier
    s_endpgm
.p2align 12
L_comp:
    s_cmp_lg_u32 s37, 1
    s_cbranch_scc1 L_nocpf
    s_getpc_b64 s[4:5]
L_pc:
    s_sub_u32 s4, s4, L_pc-concat_heads__gqa_block_cached__gqa_block_cached__near_ridge_kernel
    s_subb_u32 s5, s5, 0
    s_mov_b32 s6, L_end-concat_heads__gqa_block_cached__gqa_block_cached__near_ridge_kernel
    s_mov_b32 s7, 0x20000
    s_mul_i32 s8, s31, 1280
    v_lshlrev_b32_e64 v1, 7, v0
    s_mov_b64 exec, 0x3ff
    buffer_load_dword v229, v1, s[4:7], s8 offen
    s_mov_b64 exec, -1
L_nocpf:
    s_lshr_b32 s58, s31, 1
    s_and_b32 s59, s31, 1
    s_lshl_b32 s50, s32, 5
    s_add_u32 s50, s50, s31
    s_getreg_b32 s45, hwreg(HW_REG_XCC_ID, 0, 4)
    s_or_b32 s45, s45, 0x100
    s_lshl_b32 s76, s30, 12
    s_add_u32 s76, s76, 33554432
    v_lshlrev_b32 v1, 4, v0
    s_waitcnt lgkmcnt(0)
    s_mov_b32 s12, s74
    s_mov_b32 s13, s75
    s_mov_b32 s14, 50331648
    s_mov_b32 s15, 0x20000
    s_mov_b32 s16, s72
    s_mov_b32 s17, s73
    s_mov_b32 s18, 256
    s_mov_b32 s19, 0x20000
    v_mov_b32 v64, 0
    v_mov_b32 v65, 0
    v_mov_b32 v66, 0
    v_mov_b32 v67, 0
    v_mov_b32 v68, 0
    v_mov_b32 v69, 0
    v_mov_b32 v70, 0
    v_mov_b32 v71, 0
    v_mov_b32 v72, 0
    v_mov_b32 v73, 0
    v_mov_b32 v74, 0
    v_mov_b32 v75, 0
    v_mov_b32 v76, 0
    v_mov_b32 v77, 0
    v_mov_b32 v78, 0
    v_mov_b32 v79, 0
    v_mov_b32 v80, 0
    v_mov_b32 v81, 0
    v_mov_b32 v82, 0
    v_mov_b32 v83, 0
    v_mov_b32 v84, 0
    v_mov_b32 v85, 0
    v_mov_b32 v86, 0
    v_mov_b32 v87, 0
    v_mov_b32 v88, 0
    v_mov_b32 v89, 0
    v_mov_b32 v90, 0
    v_mov_b32 v91, 0
    v_mov_b32 v92, 0
    v_mov_b32 v93, 0
    v_mov_b32 v94, 0
    v_mov_b32 v95, 0
    v_mov_b32 v96, 0
    v_mov_b32 v97, 0
    v_mov_b32 v98, 0
    v_mov_b32 v99, 0
    v_mov_b32 v100, 0
    v_mov_b32 v101, 0
    v_mov_b32 v102, 0
    v_mov_b32 v103, 0
    v_mov_b32 v104, 0
    v_mov_b32 v105, 0
    v_mov_b32 v106, 0
    v_mov_b32 v107, 0
    v_mov_b32 v108, 0
    v_mov_b32 v109, 0
    v_mov_b32 v110, 0
    v_mov_b32 v111, 0
    v_mov_b32 v112, 0
    v_mov_b32 v113, 0
    v_mov_b32 v114, 0
    v_mov_b32 v115, 0
    v_mov_b32 v116, 0
    v_mov_b32 v117, 0
    v_mov_b32 v118, 0
    v_mov_b32 v119, 0
    v_mov_b32 v120, 0
    v_mov_b32 v121, 0
    v_mov_b32 v122, 0
    v_mov_b32 v123, 0
    v_mov_b32 v124, 0
    v_mov_b32 v125, 0
    v_mov_b32 v126, 0
    v_mov_b32_e64 v127, 0
    s_or_b32 s39, s31, s37
    s_cbranch_scc1 L_noinit
    buffer_store_dwordx4 v[64:67], v1, s[12:15], s76 offen offset:0 sc1
    buffer_store_dwordx4 v[64:67], v1, s[12:15], s76 offen offset:1024 sc1
    buffer_store_dwordx4 v[64:67], v1, s[12:15], s76 offen offset:2048 sc1
    v_mov_b32 v30, s45
    s_lshl_b32 s39, s30, 5
    s_mov_b64 exec, 1
    s_waitcnt vmcnt(0)
    buffer_store_dword v30, off, s[16:19], s39 sc1
    s_mov_b64 exec, -1
L_noinit:
    s_and_b32 s40, s37, 1
    s_lshr_b32 s41, s37, 1
    v_lshrrev_b32 v33, 5, v0
    v_and_b32_e64 v34, 31, v0
    v_bfe_u32 v35, v0, 2, 2
    v_bfe_u32 v36, v0, 4, 1
    v_and_b32_e64 v37, 1, v0
    v_bfe_u32 v38, v0, 1, 1
    v_lshrrev_b32 v44, 4, v0
    v_and_b32 v45, 15, v0
    v_and_b32 v46, 3, v0
    s_lshl_b32 s39, s40, 6
    v_add_u32 v30, s39, v45
    v_lshlrev_b32 v30, 7, v30
    v_lshrrev_b32 v31, 1, v45
    v_xor_b32 v31, v31, v44
    v_lshl_add_u32 v6, v31, 4, v30
    v_xor_b32_e64 v7, 64, v6
    v_lshl_add_u32 v30, v44, 3, v35
    v_lshlrev_b32_e64 v30, 8, v30
    v_lshl_add_u32 v30, v37, 3, v30
    s_lshl_b32 s39, s41, 3
    v_lshlrev_b32 v31, 2, v35
    v_xor_b32 v31, s39, v31
    v_xor_b32 v31, v31, v46
    v_xor_b32_e64 v31, v31, v36
    v_lshl_add_u32 v2, v31, 4, v30
    v_xor_b32 v3, 8, v2
    v_xor_b32 v4, 64, v2
    v_xor_b32 v5, 72, v2
    s_mov_b32 s92, 0xffff0000
    s_mov_b32 s93, s92
    v_xor_b32 v31, v44, v45
    v_lshlrev_b32_e64 v30, 8, v45
    v_lshl_add_u32 v8, v31, 4, v30
    v_xor_b32_e64 v9, 64, v8
    v_xor_b32 v10, 128, v8
    v_xor_b32 v11, 192, v8
    v_lshl_add_u32 v30, v44, 2, v35
    v_lshlrev_b32_e64 v30, 8, v30
    v_lshl_add_u32 v30, v37, 3, v30
    v_lshl_add_u32 v31, v36, 2, v35
    v_lshlrev_b32 v31, 1, v31
    v_xor_b32 v31, v31, v38
    v_lshl_add_u32 v39, v31, 4, v30
    v_add_u32 v12, 65536, v39
    v_xor_b32 v13, 32, v12
    v_xor_b32 v14, 64, v12
    v_xor_b32 v15, 96, v12
    v_xor_b32 v16, 128, v12
    v_xor_b32 v17, 160, v12
    v_xor_b32 v18, 192, v12
    v_xor_b32 v19, 224, v12
    s_xor_b32 s77, s33, 3
    s_lshl_b32 s39, s40, 1
    s_and_b32 s42, s77, 1
    s_add_u32 s39, s39, s42
    s_lshl_b32 s39, s39, 12
    v_add_u32 v232, s39, v1
    v_xor_b32 v233, 4096, v232
    s_lshl_b32 s39, s41, 7
    s_and_b32 s42, s77, 2
    s_lshl_b32 s42, s42, 5
    s_add_u32 s39, s39, s42
    v_xor_b32 v20, s39, v39
    v_xor_b32 v21, 32, v20
    v_xor_b32_e64 v22, 64, v20
    v_xor_b32 v23, 96, v20
    s_lshl_b32 s39, s34, 7
    s_lshl_b32 s42, s40, 6
    s_add_u32 s39, s39, s42
    s_and_b32 s42, s33, 1
    s_lshl_b32 s42, s42, 5
    s_add_u32 s39, s39, s42
    v_add_u32 v24, s39, v45
    v_lshlrev_b32 v24, 12, v24
    v_lshl_add_u32 v24, v44, 3, v24
    s_lshl_b32 s78, s32, 11
    s_lshl_b32 s42, s35, 8
    s_add_u32 s78, s78, s42
    s_lshl_b32 s42, s41, 7
    s_add_u32 s78, s78, s42
    s_lshr_b32 s42, s33, 1
    s_lshl_b32 s42, s42, 6
    s_add_u32 s78, s78, s42
    s_lshl_b32 s39, s50, 17
    s_lshl_b32 s42, s37, 13
    s_add_u32 s39, s39, s42
    s_add_u32 s39, s39, 16777216
    s_xor_b32 s42, s77, 0
    s_lshl_b32 s42, s42, 15
    s_add_u32 s80, s39, s42
    s_xor_b32 s42, s77, 1
    s_lshl_b32 s42, s42, 15
    s_add_u32 s81, s39, s42
    s_add_u32 s81, s81, 2048
    s_xor_b32 s42, s77, 2
    s_lshl_b32 s42, s42, 15
    s_add_u32 s82, s39, s42
    s_add_u32 s82, s82, 4096
    s_lshl_b32 s42, s33, 15
    s_add_u32 s84, s39, s42
    s_add_u32 s85, s84, 4096
    s_add_u32 s86, s84, 8192
    s_lshr_b32 s39, s50, 3
    s_lshl_b32 s39, s39, 12
    s_and_b32 s42, s31, 7
    s_lshl_b32 s42, s42, 7
    s_add_u32 s87, s39, s42
    s_add_u32 s87, s87, 33556480
    v_and_b32 v27, 3, v0
    v_lshlrev_b32_e64 v27, 2, v27
    s_lshl_b32 s38, s33, 3
    s_add_u32 s38, s38, s35
    s_lshl_b32 s52, s32, 4
    s_lshl_b32 s39, s34, 2
    s_add_u32 s52, s52, s39
    s_lshl_b32 s39, s40, 1
    s_add_u32 s52, s52, s39
    s_lshl_b32 s52, s52, 5
    s_add_u32 s52, s52, s38
    s_lshl_b32 s52, s52, 13
    s_lshl_b32 s39, s41, 12
    s_add_u32 s52, s52, s39
    s_add_u32 s53, s52, 262144
    s_lshl_b32 s39, s31, 2
    s_add_u32 s39, s39, s37
    s_lshl_b32 s39, s39, 2
    s_add_u32 s88, s76, s39
    s_lshl_b32 s39, s59, 2
    s_add_u32 s38, s39, s37
    s_lshl_b32 s54, s32, 4
    s_add_u32 s54, s54, s58
    s_lshl_b32 s54, s54, 2
    s_add_u32 s54, s54, s33
    s_lshl_b32 s54, s54, 3
    s_add_u32 s54, s54, s38
    s_lshl_b32 s54, s54, 13
    s_add_u32 s55, s54, 4096
    s_lshl_b32 s42, s38, 2
    s_lshr_b32 s39, s58, 2
    s_add_u32 s42, s42, s39
    s_lshl_b32 s42, s42, 4
    s_and_b32 s39, s58, 2
    s_lshl_b32 s39, s39, 1
    s_add_u32 s42, s42, s39
    v_lshl_add_u32 v26, v37, 3, s42
    s_lshl_b32 s39, s58, 3
    s_add_u32 s39, s39, s38
    s_lshl_b32 s39, s39, 2
    s_add_u32 s39, s39, 512
    s_add_u32 s89, s76, s39
    v_lshlrev_b32_e64 v25, 2, v34
    v_add_u32 v25, 1024, v25
    v_mov_b32 v30, 1280
    v_cmp_lt_u32 vcc, 31, v0
    s_nop 1
    v_cndmask_b32 v25, v25, v30, vcc
    v_cmp_lt_u32 vcc, 47, v0
    s_nop 1
    v_cndmask_b32 v25, v25, v26, vcc
    v_mov_b32 v30, s39
    v_cmp_lt_u32 vcc, 55, v0
    s_nop 1
    v_cndmask_b32 v25, v25, v30, vcc
    v_lshlrev_b32_e64 v40, 7, v34
    v_lshl_add_u32 v40, v33, 18, v40
    v_lshlrev_b32 v41, 3, v27
    s_lshl_b32 s79, s32, 7
    s_mov_b32 s46, 0x3e0293ee
    s_mov_b32 s47, s46
    s_mov_b32 s10, 0x1111
    s_lshl_b32 s39, s37, 2
    s_lshr_b32 s51, 0xc840, s39
    s_and_b32 s51, s51, 15
    s_mov_b32 s4, 0x32103210
    s_mov_b32 s5, 0x32103210
    s_mov_b32 s6, 0x76547654
    s_mov_b32 s7, 0x76547654
    s_and_b32 s8, s4, 15
    s_lshl_b32 s8, s8, 14
    s_lshr_b64 s[4:5], s[4:5], 4
    s_and_b32 s9, s6, 15
    s_lshl_b32 s9, s9, 14
    s_lshr_b64 s[6:7], s[6:7], 4
    v_add_u32 v234, s8, v2
    v_add_u32 v235, s8, v3
    v_add_u32 v236, s8, v4
    v_add_u32 v237, s8, v5
    v_add_u32 v238, s9, v6
    v_add_u32_e64 v239, s9, v7
    s_mov_b32 s49, -2
    s_sub_u32 s39, s37, 4
    s_mov_b64 exec, 0
L_wret:
    s_add_u32 s39, s39, 4
    s_cmp_eq_u32 s39, 0
    s_cbranch_scc1 L_pg0
    s_cmp_eq_u32 s39, 1
    s_cbranch_scc1 L_pg1
    s_cmp_eq_u32 s39, 2
    s_cbranch_scc1 L_pg2
    s_cmp_eq_u32 s39, 3
    s_cbranch_scc1 L_pg3
    s_cmp_eq_u32 s39, 4
    s_cbranch_scc1 L_pg4
    s_cmp_eq_u32 s39, 5
    s_cbranch_scc1 L_pg5
    s_cmp_eq_u32 s39, 6
    s_cbranch_scc1 L_pg6
    s_cmp_eq_u32 s39, 7
    s_cbranch_scc1 L_pg7
    s_cmp_eq_u32 s39, 8
    s_cbranch_scc1 L_pg8
    s_mov_b64 exec, -1
    s_barrier
    ds_read_b64_tr_b16 v[128:129], v234 offset:0
    ds_read_b64_tr_b16 v[130:131], v234 offset:1024
    ds_read_b128 v[144:147], v238 offset:0
    ds_read_b128 v[148:151], v238 offset:2048
    ds_read_b128 v[152:155], v238 offset:4096
    ds_read_b128 v[156:159], v238 offset:6144
    ds_read_b64_tr_b16 v[132:133], v235 offset:0
    ds_read_b64_tr_b16 v[134:135], v235 offset:1024
    ds_read_b64_tr_b16 v[136:137], v236 offset:0
    ds_read_b64_tr_b16 v[138:139], v236 offset:1024
    ds_read_b64_tr_b16 v[140:141], v237 offset:0
    ds_read_b64_tr_b16 v[142:143], v237 offset:1024
    s_branch L1_cin
L1_cloop:
    s_waitcnt lgkmcnt(8)
    v_mfma_f32_16x16x32_bf16 v[64:67], v[128:131], v[144:147], v[64:67]
    ds_read_b64_tr_b16 v[160:161], v234 offset:8192
    v_mfma_f32_16x16x32_bf16 v[68:71], v[128:131], v[148:151], v[68:71]
    ds_read_b64_tr_b16 v[162:163], v234 offset:9216
    s_waitcnt lgkmcnt(8)
    v_mfma_f32_16x16x32_bf16 v[80:83], v[128:131], v[152:155], v[80:83]
    ds_read_b128 v[176:179], v239 offset:0
    v_mfma_f32_16x16x32_bf16 v[84:87], v[128:131], v[156:159], v[84:87]
    ds_read_b128 v[180:183], v239 offset:2048
    s_waitcnt lgkmcnt(8)
    v_mfma_f32_16x16x32_bf16 v[72:75], v[132:135], v[144:147], v[72:75]
    ds_read_b128 v[184:187], v239 offset:4096
    v_mfma_f32_16x16x32_bf16 v[76:79], v[132:135], v[148:151], v[76:79]
    ds_read_b128 v[188:191], v239 offset:6144
    v_mfma_f32_16x16x32_bf16 v[88:91], v[132:135], v[152:155], v[88:91]
    ds_read_b64_tr_b16 v[164:165], v235 offset:8192
    v_mfma_f32_16x16x32_bf16 v[92:95], v[132:135], v[156:159], v[92:95]
    ds_read_b64_tr_b16 v[166:167], v235 offset:9216
    s_waitcnt lgkmcnt(10)
    v_mfma_f32_16x16x32_bf16 v[96:99], v[136:139], v[144:147], v[96:99]
    ds_read_b64_tr_b16 v[168:169], v236 offset:8192
    v_mfma_f32_16x16x32_bf16 v[100:103], v[136:139], v[148:151], v[100:103]
    ds_read_b64_tr_b16 v[170:171], v236 offset:9216
    v_mfma_f32_16x16x32_bf16 v[112:115], v[136:139], v[152:155], v[112:115]
    ds_read_b64_tr_b16 v[172:173], v237 offset:8192
    v_mfma_f32_16x16x32_bf16 v[116:119], v[136:139], v[156:159], v[116:119]
    ds_read_b64_tr_b16 v[174:175], v237 offset:9216
    s_bitcmp1_b32 s10, s49
    s_cbranch_scc1 L1_hook
L1_hret:
    s_waitcnt lgkmcnt(12)
    v_mfma_f32_16x16x32_bf16 v[104:107], v[140:143], v[144:147], v[104:107]
    s_and_b32 s8, s4, 15
    s_lshl_b32 s8, s8, 14
    v_mfma_f32_16x16x32_bf16 v[108:111], v[140:143], v[148:151], v[108:111]
    s_lshr_b64 s[4:5], s[4:5], 4
    s_and_b32 s9, s6, 15
    v_mfma_f32_16x16x32_bf16 v[120:123], v[140:143], v[152:155], v[120:123]
    s_lshl_b32 s9, s9, 14
    s_lshr_b64 s[6:7], s[6:7], 4
    v_mfma_f32_16x16x32_bf16 v[124:127], v[140:143], v[156:159], v[124:127]
    s_waitcnt lgkmcnt(8)
    v_mfma_f32_16x16x32_bf16 v[64:67], v[160:163], v[176:179], v[64:67]
    v_add_u32 v234, s8, v2
    v_add_u32_e64 v235, s8, v3
    v_mfma_f32_16x16x32_bf16 v[68:71], v[160:163], v[180:183], v[68:71]
    v_add_u32_e64 v236, s8, v4
    v_add_u32 v237, s8, v5
    s_waitcnt lgkmcnt(6)
    v_mfma_f32_16x16x32_bf16 v[80:83], v[160:163], v[184:187], v[80:83]
    v_add_u32 v238, s9, v6
    v_add_u32 v239, s9, v7
    v_mfma_f32_16x16x32_bf16 v[84:87], v[160:163], v[188:191], v[84:87]
    s_waitcnt lgkmcnt(0)
    s_barrier
    ds_read_b64_tr_b16 v[128:129], v234 offset:0
    v_mfma_f32_16x16x32_bf16 v[72:75], v[164:167], v[176:179], v[72:75]
    ds_read_b64_tr_b16 v[130:131], v234 offset:1024
    v_mfma_f32_16x16x32_bf16 v[76:79], v[164:167], v[180:183], v[76:79]
    ds_read_b128 v[144:147], v238 offset:0
    v_mfma_f32_16x16x32_bf16 v[88:91], v[164:167], v[184:187], v[88:91]
    ds_read_b128 v[148:151], v238 offset:2048
    v_mfma_f32_16x16x32_bf16 v[92:95], v[164:167], v[188:191], v[92:95]
    ds_read_b128 v[152:155], v238 offset:4096
    v_mfma_f32_16x16x32_bf16 v[96:99], v[168:171], v[176:179], v[96:99]
    ds_read_b128 v[156:159], v238 offset:6144
    v_mfma_f32_16x16x32_bf16 v[100:103], v[168:171], v[180:183], v[100:103]
    ds_read_b64_tr_b16 v[132:133], v235 offset:0
    v_mfma_f32_16x16x32_bf16 v[112:115], v[168:171], v[184:187], v[112:115]
    ds_read_b64_tr_b16 v[134:135], v235 offset:1024
    v_mfma_f32_16x16x32_bf16 v[116:119], v[168:171], v[188:191], v[116:119]
    ds_read_b64_tr_b16 v[136:137], v236 offset:0
    v_mfma_f32_16x16x32_bf16 v[104:107], v[172:175], v[176:179], v[104:107]
    ds_read_b64_tr_b16 v[138:139], v236 offset:1024
    v_mfma_f32_16x16x32_bf16 v[108:111], v[172:175], v[180:183], v[108:111]
    ds_read_b64_tr_b16 v[140:141], v237 offset:0
    v_mfma_f32_16x16x32_bf16 v[120:123], v[172:175], v[184:187], v[120:123]
    ds_read_b64_tr_b16 v[142:143], v237 offset:1024
    v_mfma_f32_16x16x32_bf16 v[124:127], v[172:175], v[188:191], v[124:127]
L1_cin:
    s_waitcnt lgkmcnt(8)
    v_mfma_f32_16x16x32_bf16 v[64:67], v[128:131], v[144:147], v[64:67]
    ds_read_b64_tr_b16 v[160:161], v234 offset:8192
    v_mfma_f32_16x16x32_bf16 v[68:71], v[128:131], v[148:151], v[68:71]
    ds_read_b64_tr_b16 v[162:163], v234 offset:9216
    s_waitcnt lgkmcnt(8)
    v_mfma_f32_16x16x32_bf16 v[80:83], v[128:131], v[152:155], v[80:83]
    ds_read_b128 v[176:179], v239 offset:0
    v_mfma_f32_16x16x32_bf16 v[84:87], v[128:131], v[156:159], v[84:87]
    ds_read_b128 v[180:183], v239 offset:2048
    s_waitcnt lgkmcnt(8)
    v_mfma_f32_16x16x32_bf16 v[72:75], v[132:135], v[144:147], v[72:75]
    ds_read_b128 v[184:187], v239 offset:4096
    v_mfma_f32_16x16x32_bf16 v[76:79], v[132:135], v[148:151], v[76:79]
    ds_read_b128 v[188:191], v239 offset:6144
    v_mfma_f32_16x16x32_bf16 v[88:91], v[132:135], v[152:155], v[88:91]
    ds_read_b64_tr_b16 v[164:165], v235 offset:8192
    v_mfma_f32_16x16x32_bf16 v[92:95], v[132:135], v[156:159], v[92:95]
    ds_read_b64_tr_b16 v[166:167], v235 offset:9216
    s_waitcnt lgkmcnt(10)
    v_mfma_f32_16x16x32_bf16 v[96:99], v[136:139], v[144:147], v[96:99]
    ds_read_b64_tr_b16 v[168:169], v236 offset:8192
    v_mfma_f32_16x16x32_bf16 v[100:103], v[136:139], v[148:151], v[100:103]
    ds_read_b64_tr_b16 v[170:171], v236 offset:9216
    v_mfma_f32_16x16x32_bf16 v[112:115], v[136:139], v[152:155], v[112:115]
    ds_read_b64_tr_b16 v[172:173], v237 offset:8192
    v_mfma_f32_16x16x32_bf16 v[116:119], v[136:139], v[156:159], v[116:119]
    ds_read_b64_tr_b16 v[174:175], v237 offset:9216
    s_waitcnt lgkmcnt(12)
    v_mfma_f32_16x16x32_bf16 v[104:107], v[140:143], v[144:147], v[104:107]
    s_and_b32 s8, s4, 15
    s_lshl_b32 s8, s8, 14
    v_mfma_f32_16x16x32_bf16 v[108:111], v[140:143], v[148:151], v[108:111]
    s_lshr_b64 s[4:5], s[4:5], 4
    s_and_b32 s9, s6, 15
    v_mfma_f32_16x16x32_bf16 v[120:123], v[140:143], v[152:155], v[120:123]
    s_lshl_b32 s9, s9, 14
    s_lshr_b64 s[6:7], s[6:7], 4
    v_mfma_f32_16x16x32_bf16 v[124:127], v[140:143], v[156:159], v[124:127]
    s_add_u32 s49, s49, 2
    s_cmp_eq_u32 s49, 14
    s_cbranch_scc1 L1_clast
    s_waitcnt lgkmcnt(8)
    v_mfma_f32_16x16x32_bf16 v[64:67], v[160:163], v[176:179], v[64:67]
    v_add_u32 v234, s8, v2
    v_add_u32_e64 v235, s8, v3
    v_mfma_f32_16x16x32_bf16 v[68:71], v[160:163], v[180:183], v[68:71]
    v_add_u32_e64 v236, s8, v4
    v_add_u32 v237, s8, v5
    s_waitcnt lgkmcnt(6)
    v_mfma_f32_16x16x32_bf16 v[80:83], v[160:163], v[184:187], v[80:83]
    v_add_u32 v238, s9, v6
    v_add_u32 v239, s9, v7
    v_mfma_f32_16x16x32_bf16 v[84:87], v[160:163], v[188:191], v[84:87]
    s_waitcnt lgkmcnt(0)
    s_barrier
    ds_read_b64_tr_b16 v[128:129], v234 offset:0
    v_mfma_f32_16x16x32_bf16 v[72:75], v[164:167], v[176:179], v[72:75]
    ds_read_b64_tr_b16 v[130:131], v234 offset:1024
    v_mfma_f32_16x16x32_bf16 v[76:79], v[164:167], v[180:183], v[76:79]
    ds_read_b128 v[144:147], v238 offset:0
    v_mfma_f32_16x16x32_bf16 v[88:91], v[164:167], v[184:187], v[88:91]
    ds_read_b128 v[148:151], v238 offset:2048
    v_mfma_f32_16x16x32_bf16 v[92:95], v[164:167], v[188:191], v[92:95]
    ds_read_b128 v[152:155], v238 offset:4096
    v_mfma_f32_16x16x32_bf16 v[96:99], v[168:171], v[176:179], v[96:99]
    ds_read_b128 v[156:159], v238 offset:6144
    v_mfma_f32_16x16x32_bf16 v[100:103], v[168:171], v[180:183], v[100:103]
    ds_read_b64_tr_b16 v[132:133], v235 offset:0
    v_mfma_f32_16x16x32_bf16 v[112:115], v[168:171], v[184:187], v[112:115]
    ds_read_b64_tr_b16 v[134:135], v235 offset:1024
    v_mfma_f32_16x16x32_bf16 v[116:119], v[168:171], v[188:191], v[116:119]
    ds_read_b64_tr_b16 v[136:137], v236 offset:0
    v_mfma_f32_16x16x32_bf16 v[104:107], v[172:175], v[176:179], v[104:107]
    ds_read_b64_tr_b16 v[138:139], v236 offset:1024
    v_mfma_f32_16x16x32_bf16 v[108:111], v[172:175], v[180:183], v[108:111]
    ds_read_b64_tr_b16 v[140:141], v237 offset:0
    v_mfma_f32_16x16x32_bf16 v[120:123], v[172:175], v[184:187], v[120:123]
    ds_read_b64_tr_b16 v[142:143], v237 offset:1024
    v_mfma_f32_16x16x32_bf16 v[124:127], v[172:175], v[188:191], v[124:127]
    s_branch L1_cloop
L1_hook:
    s_cmp_lg_u32 s49, s51
    s_cbranch_scc1 L_h1q
    buffer_load_dword v228, v40, s[12:15], s52 offen sc1
L_h1q:
    s_bitcmp1_b32 s49, 1
    s_cbranch_scc1 L1_hret
    s_lshr_b32 s11, s49, 2
    s_cmp_lg_u32 s11, 3
    s_cbranch_scc1 L_h1b
    buffer_load_dword v42, v25, s[12:15], s76 offen sc1
    s_branch L1_hret
L_h1b:
    s_cmp_lg_u32 s37, 0
    s_cbranch_scc1 L1_hret
    s_cmp_eq_u32 s11, 0
    s_cbranch_scc1 L1_hret
    s_mov_b32 s56, 0
    s_cmp_eq_u32 s11, 2
    s_waitcnt vmcnt(0)
    s_cbranch_scc1 L_h1c
    buffer_load_dword v42, v41, s[16:19], s79 offen sc1
    s_branch L1_hret
L_h1d:
    buffer_load_dword v42, v41, s[16:19], s79 offen sc1
    s_add_u32 s56, s56, 1
    s_cmp_ge_u32 s56, 262144
    s_cbranch_scc1 L_h1e
    s_waitcnt vmcnt(0)
L_h1c:
    v_cmp_eq_u32 vcc, 0, v42
    s_nop 0
    s_cbranch_vccnz L_h1d
L_h1e:
    v_readlane_b32 s42, v42, s33
    v_mov_b32 v43, 1
    s_lshl_b32 s39, s31, 2
    s_add_u32 s39, s39, s76
    s_mov_b64 exec, 1
    s_cmp_eq_u32 s42, s45
    s_cbranch_scc1 L_h1f
    buffer_store_dword v43, off, s[12:15], s76 offset:1280 sc1
    s_mov_b64 exec, -1
    s_branch L1_hret
L_h1f:
    buffer_store_dword v43, off, s[12:15], s39 offset:1024
    s_mov_b64 exec, -1
    s_branch L1_hret
L_pg0:
    s_cbranch_execz L_wret
L1_clast:
    s_waitcnt lgkmcnt(9)
    v_mfma_f32_16x16x32_bf16 v[64:67], v[160:163], v[176:179], v[64:67]
    v_add_u32_e64 v234, s8, v2
    v_add_u32 v235, s8, v3
    s_waitcnt lgkmcnt(8)
    v_mfma_f32_16x16x32_bf16 v[68:71], v[160:163], v[180:183], v[68:71]
    v_add_u32_e64 v236, s8, v4
    v_add_u32 v237, s8, v5
    s_waitcnt lgkmcnt(7)
    v_mfma_f32_16x16x32_bf16 v[80:83], v[160:163], v[184:187], v[80:83]
    v_add_u32_e64 v238, s9, v6
    v_add_u32 v239, s9, v7
    s_waitcnt lgkmcnt(6)
    v_mfma_f32_16x16x32_bf16 v[84:87], v[160:163], v[188:191], v[84:87]
    s_waitcnt lgkmcnt(0)
    s_barrier
    ds_read_b64_tr_b16 v[128:129], v234 offset:0
    ds_read_b64_tr_b16 v[130:131], v234 offset:1024
    ds_read_b128 v[132:135], v238 offset:0
    v_mfma_f32_16x16x32_bf16 v[72:75], v[164:167], v[176:179], v[72:75]
    ds_read_b64_tr_b16 v[136:137], v235 offset:0
    v_mfma_f32_16x16x32_bf16 v[76:79], v[164:167], v[180:183], v[76:79]
    ds_read_b64_tr_b16 v[138:139], v235 offset:1024
    ds_read_b128 v[140:143], v238 offset:2048
    v_mfma_f32_16x16x32_bf16 v[88:91], v[164:167], v[184:187], v[88:91]
    ds_read_b64_tr_b16 v[144:145], v234 offset:8192
    v_mfma_f32_16x16x32_bf16 v[92:95], v[164:167], v[188:191], v[92:95]
    ds_read_b64_tr_b16 v[146:147], v234 offset:9216
    ds_read_b128 v[148:151], v239 offset:0
    v_mfma_f32_16x16x32_bf16 v[96:99], v[168:171], v[176:179], v[96:99]
    ds_read_b64_tr_b16 v[152:153], v235 offset:8192
    v_mfma_f32_16x16x32_bf16 v[100:103], v[168:171], v[180:183], v[100:103]
    ds_read_b64_tr_b16 v[154:155], v235 offset:9216
    ds_read_b128 v[156:159], v239 offset:2048
    v_mfma_f32_16x16x32_bf16 v[112:115], v[168:171], v[184:187], v[112:115]
    ds_read_b128 v[192:195], v238 offset:4096
    v_mfma_f32_16x16x32_bf16 v[116:119], v[168:171], v[188:191], v[116:119]
    ds_read_b128 v[196:199], v238 offset:6144
    ds_read_b128 v[200:203], v239 offset:4096
    v_mfma_f32_16x16x32_bf16 v[104:107], v[172:175], v[176:179], v[104:107]
    ds_read_b128 v[204:207], v239 offset:6144
    v_mfma_f32_16x16x32_bf16 v[108:111], v[172:175], v[180:183], v[108:111]
    ds_read_b64_tr_b16 v[208:209], v236 offset:0
    ds_read_b64_tr_b16 v[210:211], v236 offset:1024
    v_mfma_f32_16x16x32_bf16 v[120:123], v[172:175], v[184:187], v[120:123]
    ds_read_b64_tr_b16 v[212:213], v237 offset:0
    v_mfma_f32_16x16x32_bf16 v[124:127], v[172:175], v[188:191], v[124:127]
    ds_read_b64_tr_b16 v[214:215], v237 offset:1024
    ds_read_b64_tr_b16 v[216:217], v236 offset:8192
    s_waitcnt lgkmcnt(15)
    v_mfma_f32_16x16x32_bf16 v[64:67], v[128:131], v[132:135], v[64:67]
    ds_read_b64_tr_b16 v[218:219], v236 offset:9216
    v_mfma_f32_16x16x32_bf16 v[72:75], v[136:139], v[132:135], v[72:75]
    ds_read_b64_tr_b16 v[220:221], v237 offset:8192
    ds_read_b64_tr_b16 v[222:223], v237 offset:9216
    v_mfma_f32_16x16x32_bf16 v[68:71], v[128:131], v[140:143], v[68:71]
    v_mfma_f32_16x16x32_bf16 v[76:79], v[136:139], v[140:143], v[76:79]
    s_waitcnt lgkmcnt(12)
    v_mfma_f32_16x16x32_bf16 v[64:67], v[144:147], v[148:151], v[64:67]
    s_mov_b32 s56, 0
L_mode:
    s_waitcnt vmcnt(0)
    v_cmp_eq_u32 vcc, 1, v42
    s_nop 0
    s_cmp_eq_u32 vcc_lo, -1
    s_cselect_b32 s57, 1, 0
    s_cbranch_scc1 L_mode_ok
    s_bitcmp1_b32 vcc_hi, 0
    s_cbranch_scc1 L_mode_ok
    buffer_load_dword v42, v25, s[12:15], s76 offen sc1
    s_add_u32 s56, s56, 1
    s_cmp_lt_u32 s56, 262144
    s_cbranch_scc1 L_mode
L_mode_ok:
    v_mfma_f32_16x16x32_bf16 v[72:75], v[152:155], v[148:151], v[72:75]
    v_mfma_f32_16x16x32_bf16 v[68:71], v[144:147], v[156:159], v[68:71]
    v_mfma_f32_16x16x32_bf16 v[76:79], v[152:155], v[156:159], v[76:79]
    s_waitcnt lgkmcnt(10)
    v_mfma_f32_16x16x32_bf16 v[80:83], v[128:131], v[192:195], v[80:83]
    v_mfma_f32_16x16x32_bf16 v[88:91], v[136:139], v[192:195], v[88:91]
    v_pk_mul_f32 v[64:65], v[64:65], s[46:47]
    v_pk_mul_f32 v[66:67], v[66:67], s[46:47]
    s_nop 0
    v_pk_mul_f32 v[72:73], v[72:73], s[46:47]
    v_mfma_f32_16x16x32_bf16 v[84:87], v[128:131], v[196:199], v[84:87]
    v_pk_mul_f32 v[74:75], v[74:75], s[46:47]
    v_cvt_pk_bf16_f32 v64, v64, v65
    v_cvt_pk_bf16_f32 v65, v66, v67
    v_mfma_f32_16x16x32_bf16 v[92:95], v[136:139], v[196:199], v[92:95]
    v_cvt_pk_bf16_f32 v72, v72, v73
    v_cvt_pk_bf16_f32 v73, v74, v75
    v_cndmask_b32 v48, v64, v72, s[92:93]
    s_waitcnt lgkmcnt(8)
    v_mfma_f32_16x16x32_bf16 v[80:83], v[144:147], v[200:203], v[80:83]
    v_cndmask_b32 v49, v65, v73, s[92:93]
    v_cndmask_b32 v50, v72, v64, s[92:93]
    v_cndmask_b32 v51, v73, v65, s[92:93]
    v_mfma_f32_16x16x32_bf16 v[88:91], v[152:155], v[200:203], v[88:91]
    buffer_store_dwordx4 v[48:51], v1, s[12:15], s52 offen offset:0
    v_pk_mul_f32 v[68:69], v[68:69], s[46:47]
    v_pk_mul_f32 v[70:71], v[70:71], s[46:47]
    v_mfma_f32_16x16x32_bf16 v[84:87], v[144:147], v[204:207], v[84:87]
    v_pk_mul_f32 v[76:77], v[76:77], s[46:47]
    v_pk_mul_f32 v[78:79], v[78:79], s[46:47]
    v_cvt_pk_bf16_f32 v68, v68, v69
    v_mfma_f32_16x16x32_bf16 v[92:95], v[152:155], v[204:207], v[92:95]
    v_cvt_pk_bf16_f32 v69, v70, v71
    v_cvt_pk_bf16_f32 v76, v76, v77
    v_cvt_pk_bf16_f32 v77, v78, v79
    s_waitcnt lgkmcnt(4)
    v_mfma_f32_16x16x32_bf16 v[96:99], v[208:211], v[132:135], v[96:99]
    v_cndmask_b32 v52, v68, v76, s[92:93]
    v_cndmask_b32 v53, v69, v77, s[92:93]
    v_cndmask_b32 v54, v76, v68, s[92:93]
    v_mfma_f32_16x16x32_bf16 v[104:107], v[212:215], v[132:135], v[104:107]
    v_cndmask_b32 v55, v77, v69, s[92:93]
    buffer_store_dwordx4 v[52:55], v1, s[12:15], s52 offen offset:1024
    v_pk_mul_f32 v[80:81], v[80:81], s[46:47]
    v_mfma_f32_16x16x32_bf16 v[100:103], v[208:211], v[140:143], v[100:103]
    v_pk_mul_f32 v[82:83], v[82:83], s[46:47]
    v_pk_mul_f32 v[88:89], v[88:89], s[46:47]
    v_pk_mul_f32 v[90:91], v[90:91], s[46:47]
    v_mfma_f32_16x16x32_bf16 v[108:111], v[212:215], v[140:143], v[108:111]
    v_cvt_pk_bf16_f32 v80, v80, v81
    v_cvt_pk_bf16_f32 v81, v82, v83
    v_cvt_pk_bf16_f32 v88, v88, v89
    s_waitcnt lgkmcnt(2)
    v_mfma_f32_16x16x32_bf16 v[96:99], v[216:219], v[148:151], v[96:99]
    v_cvt_pk_bf16_f32 v89, v90, v91
    v_cndmask_b32 v56, v80, v88, s[92:93]
    v_cndmask_b32 v57, v81, v89, s[92:93]
    s_waitcnt lgkmcnt(0)
    v_mfma_f32_16x16x32_bf16 v[104:107], v[220:223], v[148:151], v[104:107]
    v_cndmask_b32 v58, v88, v80, s[92:93]
    v_cndmask_b32 v59, v89, v81, s[92:93]
    buffer_store_dwordx4 v[56:59], v1, s[12:15], s53 offen offset:0
    v_mfma_f32_16x16x32_bf16 v[100:103], v[216:219], v[156:159], v[100:103]
    v_pk_mul_f32 v[84:85], v[84:85], s[46:47]
    v_pk_mul_f32 v[86:87], v[86:87], s[46:47]
    v_pk_mul_f32 v[92:93], v[92:93], s[46:47]
    v_mfma_f32_16x16x32_bf16 v[108:111], v[220:223], v[156:159], v[108:111]
    v_pk_mul_f32 v[94:95], v[94:95], s[46:47]
    v_cvt_pk_bf16_f32 v84, v84, v85
    v_cvt_pk_bf16_f32 v85, v86, v87
    v_mfma_f32_16x16x32_bf16 v[112:115], v[208:211], v[192:195], v[112:115]
    v_cvt_pk_bf16_f32 v92, v92, v93
    v_cvt_pk_bf16_f32 v93, v94, v95
    v_cndmask_b32 v60, v84, v92, s[92:93]
    v_mfma_f32_16x16x32_bf16 v[120:123], v[212:215], v[192:195], v[120:123]
    v_cndmask_b32 v61, v85, v93, s[92:93]
    v_cndmask_b32 v62, v92, v84, s[92:93]
    v_cndmask_b32 v63, v93, v85, s[92:93]
    v_mfma_f32_16x16x32_bf16 v[116:119], v[208:211], v[196:199], v[116:119]
    buffer_store_dwordx4 v[60:63], v1, s[12:15], s53 offen offset:1024
    v_pk_mul_f32 v[96:97], v[96:97], s[46:47]
L_pg1:
    s_cbranch_execz L_wret
    v_pk_mul_f32 v[98:99], v[98:99], s[46:47]
    v_mfma_f32_16x16x32_bf16 v[124:127], v[212:215], v[196:199], v[124:127]
    v_pk_mul_f32 v[104:105], v[104:105], s[46:47]
    v_pk_mul_f32 v[106:107], v[106:107], s[46:47]
    v_cvt_pk_bf16_f32 v96, v96, v97
    v_mfma_f32_16x16x32_bf16 v[112:115], v[216:219], v[200:203], v[112:115]
    v_cvt_pk_bf16_f32 v97, v98, v99
    v_cvt_pk_bf16_f32 v104, v104, v105
    v_cvt_pk_bf16_f32 v105, v106, v107
    v_mfma_f32_16x16x32_bf16 v[120:123], v[220:223], v[200:203], v[120:123]
    v_cndmask_b32 v48, v96, v104, s[92:93]
    v_cndmask_b32 v49, v97, v105, s[92:93]
    v_cndmask_b32 v50, v104, v96, s[92:93]
    v_mfma_f32_16x16x32_bf16 v[116:119], v[216:219], v[204:207], v[116:119]
    v_cndmask_b32 v51, v105, v97, s[92:93]
    buffer_store_dwordx4 v[48:51], v1, s[12:15], s52 offen offset:2048
    v_pk_mul_f32 v[100:101], v[100:101], s[46:47]
    v_mfma_f32_16x16x32_bf16 v[124:127], v[220:223], v[204:207], v[124:127]
    v_pk_mul_f32 v[102:103], v[102:103], s[46:47]
    v_pk_mul_f32 v[108:109], v[108:109], s[46:47]
    v_pk_mul_f32 v[110:111], v[110:111], s[46:47]
    v_cvt_pk_bf16_f32 v100, v100, v101
    v_cvt_pk_bf16_f32 v101, v102, v103
    v_cvt_pk_bf16_f32 v108, v108, v109
    v_cvt_pk_bf16_f32 v109, v110, v111
    v_cndmask_b32 v52, v100, v108, s[92:93]
    v_cndmask_b32 v53, v101, v109, s[92:93]
    v_cndmask_b32 v54, v108, v100, s[92:93]
    v_cndmask_b32 v55, v109, v101, s[92:93]
    buffer_store_dwordx4 v[52:55], v1, s[12:15], s52 offen offset:3072
    v_pk_mul_f32 v[112:113], v[112:113], s[46:47]
    v_pk_mul_f32 v[114:115], v[114:115], s[46:47]
    v_pk_mul_f32 v[120:121], v[120:121], s[46:47]
    v_pk_mul_f32 v[122:123], v[122:123], s[46:47]
    v_cvt_pk_bf16_f32 v112, v112, v113
    v_cvt_pk_bf16_f32 v113, v114, v115
    v_cvt_pk_bf16_f32 v120, v120, v121
    v_cvt_pk_bf16_f32 v121, v122, v123
    v_cndmask_b32 v56, v112, v120, s[92:93]
    v_cndmask_b32 v57, v113, v121, s[92:93]
    v_cndmask_b32 v58, v120, v112, s[92:93]
    v_cndmask_b32 v59, v121, v113, s[92:93]
    buffer_store_dwordx4 v[56:59], v1, s[12:15], s53 offen offset:2048
    v_pk_mul_f32 v[116:117], v[116:117], s[46:47]
    v_pk_mul_f32 v[118:119], v[118:119], s[46:47]
    v_pk_mul_f32 v[124:125], v[124:125], s[46:47]
    v_pk_mul_f32 v[126:127], v[126:127], s[46:47]
    v_cvt_pk_bf16_f32 v116, v116, v117
    v_cvt_pk_bf16_f32 v117, v118, v119
    v_cvt_pk_bf16_f32 v124, v124, v125
    v_cvt_pk_bf16_f32 v125, v126, v127
    v_cndmask_b32 v60, v116, v124, s[92:93]
    v_cndmask_b32 v61, v117, v125, s[92:93]
    v_cndmask_b32 v62, v124, v116, s[92:93]
    v_cndmask_b32 v63, v125, v117, s[92:93]
    buffer_store_dwordx4 v[60:63], v1, s[12:15], s53 offen offset:3072
    v_mov_b32_e64 v31, 1
    s_mov_b64 exec, 1
    s_cmp_eq_u32 s57, 1
    s_waitcnt vmcnt(0)
    s_cbranch_scc1 L_qpub_f
    buffer_wbl2 sc1
    s_waitcnt vmcnt(0)
    buffer_store_dword v31, off, s[12:15], s88 sc1
    s_branch L_qpub_d
L_qpub_f:
    buffer_store_dword v31, off, s[12:15], s88
L_qpub_d:
    s_mov_b64 exec, -1
    s_mov_b32 s56, 0
L_qpoll:
    buffer_load_dword v31, v26, s[12:15], s76 offen sc1
    s_add_u32 s56, s56, 1
    s_cmp_ge_u32 s56, 262144
    s_cbranch_scc1 L_qpoll_go
    s_waitcnt vmcnt(0)
L_qpoll_chk:
    v_cmp_eq_u32 vcc, 1, v31
    s_nop 0
    s_cmp_eq_u64 vcc, -1
    s_cbranch_scc0 L_qpoll
L_qpoll_go:
    s_cmp_eq_u32 s57, 1
    s_cbranch_scc1 L_qacq
    buffer_inv sc1
    s_waitcnt vmcnt(0)
L_qacq:
    buffer_load_dwordx4 v[32:35], v1, s[12:15], s54 offen offset:0 sc1
    buffer_load_dwordx4 v[36:39], v1, s[12:15], s54 offen offset:1024 sc1
    buffer_load_dwordx4 v[40:43], v1, s[12:15], s54 offen offset:2048 sc1
    buffer_load_dwordx4 v[44:47], v1, s[12:15], s54 offen offset:3072 sc1
    buffer_load_dwordx4 v[48:51], v1, s[12:15], s55 offen offset:0 sc1
    buffer_load_dwordx4 v[52:55], v1, s[12:15], s55 offen offset:1024 sc1
    buffer_load_dwordx4 v[56:59], v1, s[12:15], s55 offen offset:2048 sc1
    buffer_load_dwordx4 v[60:63], v1, s[12:15], s55 offen offset:3072 sc1
    v_mov_b32 v176, -1
    v_mov_b32 v177, -1
    v_mov_b32 v178, -1
    v_mov_b32 v179, -1
    s_waitcnt lgkmcnt(0)
    s_barrier
    ds_read_b128 v[192:195], v8 offset:0
    ds_read_b128 v[196:199], v8 offset:4096
    ds_read_b128 v[200:203], v9 offset:0
    ds_read_b128 v[204:207], v9 offset:4096
    ds_read_b128 v[208:211], v10 offset:0
    ds_read_b128 v[212:215], v10 offset:4096
    s_mov_b32 s90, s80
    v_or_b32 v5, s37, v0
    v_lshlrev_b32 v5, 26, v5
    s_lshl_b32 s39, s33, 2
    v_add_u32 v5, s39, v5
    v_mov_b32 v6, 1
    v_mov_b32 v64, 0
    v_mov_b32 v65, 0
    v_mov_b32 v66, 0
    v_mov_b32 v67, 0
    v_mov_b32 v68, 0
    v_mov_b32 v69, 0
    v_mov_b32 v70, 0
    v_mov_b32 v71, 0
    v_mov_b32 v72, 0
    v_mov_b32 v73, 0
    v_mov_b32 v74, 0
    v_mov_b32 v75, 0
    v_mov_b32 v76, 0
    v_mov_b32 v77, 0
    v_mov_b32 v78, 0
    v_mov_b32 v79, 0
    v_mov_b32 v80, 0
    v_mov_b32 v81, 0
    v_mov_b32 v82, 0
    v_mov_b32 v83, 0
    v_mov_b32 v84, 0
    v_mov_b32 v85, 0
    v_mov_b32 v86, 0
    v_mov_b32 v87, 0
    v_mov_b32 v88, 0
    v_mov_b32 v89, 0
    v_mov_b32 v90, 0
    v_mov_b32 v91, 0
    v_mov_b32 v92, 0
    v_mov_b32 v93, 0
    v_mov_b32 v94, 0
    v_mov_b32 v95, 0
    v_mov_b32 v96, 0
    v_mov_b32 v97, 0
    v_mov_b32 v98, 0
    v_mov_b32 v99, 0
    v_mov_b32 v100, 0
    v_mov_b32 v101, 0
    v_mov_b32 v102, 0
    v_mov_b32 v103, 0
    v_mov_b32 v104, 0
    v_mov_b32 v105, 0
    v_mov_b32 v106, 0
    v_mov_b32 v107, 0
    v_mov_b32 v108, 0
    v_mov_b32 v109, 0
    v_mov_b32 v110, 0
    v_mov_b32 v111, 0
    v_mov_b32 v112, 0
    v_mov_b32 v113, 0
    v_mov_b32 v114, 0
    v_mov_b32 v115, 0
    v_mov_b32 v116, 0
    v_mov_b32 v117, 0
    v_mov_b32 v118, 0
    v_mov_b32 v119, 0
    v_mov_b32 v120, 0
    v_mov_b32 v121, 0
    v_mov_b32 v122, 0
    v_mov_b32 v123, 0
    v_mov_b32 v124, 0
    v_mov_b32 v125, 0
    v_mov_b32 v126, 0
    v_mov_b32 v127, 0
    v_mov_b32 v28, 0
    v_mov_b32 v29, 0
    v_mov_b32 v240, 0
    v_mov_b32 v241, 0
    v_mov_b32 v242, 0
    v_mov_b32 v243, 0
    v_mov_b32 v244, 0
    v_mov_b32 v245, 0
    v_mov_b32 v246, 0
    v_mov_b32 v247, 0
    v_lshrrev_b32 v228, 4, v0
    v_xor_b32 v228, v228, v0
    v_and_b32_e64 v228, 2, v228
    v_mov_b32 v229, 0x3f803f80
    v_cmp_eq_u32 vcc, 0, v228
    s_nop 1
    v_cndmask_b32 v228, 0, v229, vcc
    v_mov_b32 v229, v228
    v_mov_b32 v230, v228
    v_mov_b32 v231, v228
    v_and_b32 v244, 1, v0
    v_sub_u32 v244, 0, v244
    v_and_b32 v244, 0xaaaaaaaa, v244
    v_or_b32 v244, 0x44444444, v244
    s_mov_b32 s49, 0
    s_waitcnt vmcnt(6) lgkmcnt(5)
    v_mfma_f32_16x16x32_bf16 v[128:131], v[192:195], v[32:35], 0
    v_mfma_f32_16x16x32_bf16 v[136:139], v[192:195], v[36:39], 0
    ds_read_b128 v[216:219], v11 offset:0
    s_waitcnt vmcnt(6) lgkmcnt(5)
    v_mfma_f32_16x16x32_bf16 v[132:135], v[196:199], v[32:35], 0
    v_mfma_f32_16x16x32_bf16 v[140:143], v[196:199], v[36:39], 0
    ds_read_b128 v[220:223], v11 offset:4096
    s_waitcnt vmcnt(4) lgkmcnt(5)
    v_mfma_f32_16x16x32_bf16 v[128:131], v[200:203], v[40:43], v[128:131]
    v_mfma_f32_16x16x32_bf16 v[136:139], v[200:203], v[44:47], v[136:139]
    ds_read_b128 v[192:195], v8 offset:8192
    s_waitcnt vmcnt(4) lgkmcnt(5)
    v_mfma_f32_16x16x32_bf16 v[132:135], v[204:207], v[40:43], v[132:135]
    v_mfma_f32_16x16x32_bf16 v[140:143], v[204:207], v[44:47], v[140:143]
    ds_read_b128 v[196:199], v9 offset:8192
    s_waitcnt vmcnt(2) lgkmcnt(5)
    v_mfma_f32_16x16x32_bf16 v[128:131], v[208:211], v[48:51], v[128:131]
    v_mfma_f32_16x16x32_bf16 v[136:139], v[208:211], v[52:55], v[136:139]
    ds_read_b128 v[200:203], v10 offset:8192
    s_waitcnt vmcnt(2) lgkmcnt(5)
    v_mfma_f32_16x16x32_bf16 v[132:135], v[212:215], v[48:51], v[132:135]
    v_mfma_f32_16x16x32_bf16 v[140:143], v[212:215], v[52:55], v[140:143]
    ds_read_b128 v[204:207], v11 offset:8192
    s_waitcnt vmcnt(0) lgkmcnt(5)
    v_mfma_f32_16x16x32_bf16 v[128:131], v[216:219], v[56:59], v[128:131]
    v_mfma_f32_16x16x32_bf16 v[136:139], v[216:219], v[60:63], v[136:139]
    ds_read_b128 v[208:211], v8 offset:12288
    s_waitcnt vmcnt(0) lgkmcnt(5)
    v_mfma_f32_16x16x32_bf16 v[132:135], v[220:223], v[56:59], v[132:135]
    v_mfma_f32_16x16x32_bf16 v[140:143], v[220:223], v[60:63], v[140:143]
    ds_read_b128 v[212:215], v9 offset:12288
    s_waitcnt lgkmcnt(2)
    v_mfma_f32_16x16x32_bf16 v[144:147], v[192:195], v[32:35], 0
    v_exp_f32_e64 v224, v128
    v_mfma_f32_16x16x32_bf16 v[152:155], v[192:195], v[36:39], 0
    ds_read_b128 v[216:219], v10 offset:12288
    v_exp_f32_e64 v225, v129
    v_mfma_f32_16x16x32_bf16 v[144:147], v[196:199], v[40:43], v[144:147]
    v_exp_f32_e64 v226, v130
    v_cvt_pk_bf16_f32 v160, v224, v225
    v_mfma_f32_16x16x32_bf16 v[152:155], v[196:199], v[44:47], v[152:155]
    ds_read_b128 v[220:223], v11 offset:12288
    v_exp_f32_e64 v227, v131
    v_mfma_f32_16x16x32_bf16 v[144:147], v[200:203], v[48:51], v[144:147]
    v_exp_f32_e64 v224, v132
    v_cvt_pk_bf16_f32 v161, v226, v227
    v_mfma_f32_16x16x32_bf16 v[152:155], v[200:203], v[52:55], v[152:155]
    s_barrier
    ds_read_b128 v[192:195], v8 offset:16384
    v_exp_f32 v225, v133
    v_mfma_f32_16x16x32_bf16 v[144:147], v[204:207], v[56:59], v[144:147]
    v_exp_f32_e64 v226, v134
    v_cvt_pk_bf16_f32 v162, v224, v225
    v_mfma_f32_16x16x32_bf16 v[152:155], v[204:207], v[60:63], v[152:155]
    ds_read_b64_tr_b16 v[196:197], v12 offset:16384
    ds_read_b64_tr_b16 v[198:199], v12 offset:20480
    v_exp_f32 v227, v135
    s_waitcnt lgkmcnt(3)
    v_mfma_f32_16x16x32_bf16 v[148:151], v[208:211], v[32:35], 0
    v_exp_f32_e64 v224, v136
    v_cvt_pk_bf16_f32 v163, v226, v227
    v_mfma_f32_16x16x32_bf16 v[156:159], v[208:211], v[36:39], 0
    ds_read_b128 v[200:203], v9 offset:16384
    v_exp_f32_e64 v225, v137
    v_mfma_f32_16x16x32_bf16 v[148:151], v[212:215], v[40:43], v[148:151]
    v_exp_f32_e64 v226, v138
    v_cvt_pk_bf16_f32 v164, v224, v225
    v_mfma_f32_16x16x32_bf16 v[156:159], v[212:215], v[44:47], v[156:159]
    ds_read_b64_tr_b16 v[204:205], v13 offset:16384
    ds_read_b64_tr_b16 v[206:207], v13 offset:20480
    v_exp_f32_e64 v227, v139
    v_mfma_f32_16x16x32_bf16 v[148:151], v[216:219], v[48:51], v[148:151]
    v_exp_f32_e64 v224, v140
    v_cvt_pk_bf16_f32 v165, v226, v227
    v_mfma_f32_16x16x32_bf16 v[156:159], v[216:219], v[52:55], v[156:159]
    ds_read_b128 v[208:211], v10 offset:16384
    v_exp_f32_e64 v225, v141
    v_mfma_f32_16x16x32_bf16 v[148:151], v[220:223], v[56:59], v[148:151]
    v_exp_f32_e64 v226, v142
    v_cvt_pk_bf16_f32 v166, v224, v225
    v_mfma_f32_16x16x32_bf16 v[156:159], v[220:223], v[60:63], v[156:159]
    ds_read_b64_tr_b16 v[212:213], v14 offset:16384
    ds_read_b64_tr_b16 v[214:215], v14 offset:20480
    v_exp_f32 v227, v143
L2_cloop:
    s_waitcnt lgkmcnt(3)
    v_mfma_f32_16x16x32_bf16 v[128:131], v[192:195], v[32:35], 0
    v_exp_f32_e64 v224, v144
    v_mfma_f32_16x16x32_bf16 v[136:139], v[192:195], v[36:39], 0
    ds_read_b128 v[216:219], v11 offset:16384
    v_cvt_pk_bf16_f32 v167, v226, v227
    v_mfma_f32_16x16x32_bf16 v[64:67], v[196:199], v[160:163], v[64:67]
    v_exp_f32_e64 v225, v145
    v_mfma_f32_16x16x32_bf16 v[72:75], v[196:199], v[164:167], v[72:75]
    ds_read_b64_tr_b16 v[220:221], v15 offset:16384
    ds_read_b64_tr_b16 v[222:223], v15 offset:20480
    v_mfma_f32_16x16x32_bf16 v[128:131], v[200:203], v[40:43], v[128:131]
    v_exp_f32_e64 v226, v146
    v_mfma_f32_16x16x32_bf16 v[136:139], v[200:203], v[44:47], v[136:139]
    ds_read_b128 v[192:195], v8 offset:20480
    v_cvt_pk_bf16_f32 v168, v224, v225
    v_mfma_f32_16x16x32_bf16 v[68:71], v[204:207], v[160:163], v[68:71]
    v_exp_f32_e64 v227, v147
    v_mfma_f32_16x16x32_bf16 v[76:79], v[204:207], v[164:167], v[76:79]
    ds_read_b64_tr_b16 v[196:197], v16 offset:16384
    ds_read_b64_tr_b16 v[198:199], v16 offset:20480
    v_smfmac_f32_16x16x64_bf16 v[240:243], v[228:231], v[160:167], v244
    s_waitcnt lgkmcnt(3)
    v_mfma_f32_16x16x32_bf16 v[128:131], v[208:211], v[48:51], v[128:131]
    v_exp_f32 v224, v148
    v_mfma_f32_16x16x32_bf16 v[136:139], v[208:211], v[52:55], v[136:139]
    ds_read_b128 v[200:203], v9 offset:20480
    v_cvt_pk_bf16_f32 v169, v226, v227
    v_mfma_f32_16x16x32_bf16 v[80:83], v[212:215], v[160:163], v[80:83]
    v_exp_f32_e64 v225, v149
    v_mfma_f32_16x16x32_bf16 v[88:91], v[212:215], v[164:167], v[88:91]
    ds_read_b64_tr_b16 v[204:205], v17 offset:16384
    ds_read_b64_tr_b16 v[206:207], v17 offset:20480
    v_mfma_f32_16x16x32_bf16 v[128:131], v[216:219], v[56:59], v[128:131]
    v_exp_f32_e64 v226, v150
    v_mfma_f32_16x16x32_bf16 v[136:139], v[216:219], v[60:63], v[136:139]
    ds_read_b128 v[208:211], v10 offset:20480
    v_cvt_pk_bf16_f32 v170, v224, v225
    v_mfma_f32_16x16x32_bf16 v[84:87], v[220:223], v[160:163], v[84:87]
    v_exp_f32_e64 v227, v151
    v_mfma_f32_16x16x32_bf16 v[92:95], v[220:223], v[164:167], v[92:95]
    ds_read_b64_tr_b16 v[212:213], v18 offset:16384
    ds_read_b64_tr_b16 v[214:215], v18 offset:20480
    s_waitcnt lgkmcnt(3)
    v_mfma_f32_16x16x32_bf16 v[132:135], v[192:195], v[32:35], 0
    v_exp_f32 v224, v152
    v_mfma_f32_16x16x32_bf16 v[140:143], v[192:195], v[36:39], 0
    ds_read_b128 v[216:219], v11 offset:20480
    v_cvt_pk_bf16_f32 v171, v226, v227
    v_mfma_f32_16x16x32_bf16 v[96:99], v[196:199], v[160:163], v[96:99]
    v_exp_f32_e64 v225, v153
    v_mfma_f32_16x16x32_bf16 v[104:107], v[196:199], v[164:167], v[104:107]
    ds_read_b64_tr_b16 v[220:221], v19 offset:16384
    ds_read_b64_tr_b16 v[222:223], v19 offset:20480
    v_mfma_f32_16x16x32_bf16 v[132:135], v[200:203], v[40:43], v[132:135]
    v_exp_f32_e64 v226, v154
    v_mfma_f32_16x16x32_bf16 v[140:143], v[200:203], v[44:47], v[140:143]
    ds_read_b128 v[192:195], v8 offset:24576
    v_cvt_pk_bf16_f32 v172, v224, v225
    v_mfma_f32_16x16x32_bf16 v[100:103], v[204:207], v[160:163], v[100:103]
    v_exp_f32_e64 v227, v155
    v_mfma_f32_16x16x32_bf16 v[108:111], v[204:207], v[164:167], v[108:111]
    ds_read_b64_tr_b16 v[196:197], v12 offset:24576
    ds_read_b64_tr_b16 v[198:199], v12 offset:28672
    s_waitcnt lgkmcnt(3)
    v_mfma_f32_16x16x32_bf16 v[132:135], v[208:211], v[48:51], v[132:135]
    v_exp_f32 v224, v156
    v_mfma_f32_16x16x32_bf16 v[140:143], v[208:211], v[52:55], v[140:143]
    ds_read_b128 v[200:203], v9 offset:24576
    v_cvt_pk_bf16_f32 v173, v226, v227
    v_mfma_f32_16x16x32_bf16 v[112:115], v[212:215], v[160:163], v[112:115]
    v_exp_f32_e64 v225, v157
    v_mfma_f32_16x16x32_bf16 v[120:123], v[212:215], v[164:167], v[120:123]
    ds_read_b64_tr_b16 v[204:205], v13 offset:24576
    ds_read_b64_tr_b16 v[206:207], v13 offset:28672
    v_mfma_f32_16x16x32_bf16 v[132:135], v[216:219], v[56:59], v[132:135]
    v_exp_f32_e64 v226, v158
    v_mfma_f32_16x16x32_bf16 v[140:143], v[216:219], v[60:63], v[140:143]
    ds_read_b128 v[208:211], v10 offset:24576
    v_cvt_pk_bf16_f32 v174, v224, v225
    v_mfma_f32_16x16x32_bf16 v[116:119], v[220:223], v[160:163], v[116:119]
    v_exp_f32_e64 v227, v159
    v_mfma_f32_16x16x32_bf16 v[124:127], v[220:223], v[164:167], v[124:127]
    ds_read_b64_tr_b16 v[212:213], v14 offset:24576
    ds_read_b64_tr_b16 v[214:215], v14 offset:28672
    s_waitcnt lgkmcnt(3)
    v_mfma_f32_16x16x32_bf16 v[144:147], v[192:195], v[32:35], 0
    v_exp_f32 v224, v128
    v_mfma_f32_16x16x32_bf16 v[152:155], v[192:195], v[36:39], 0
    ds_read_b128 v[216:219], v11 offset:24576
    v_cvt_pk_bf16_f32 v175, v226, v227
    v_mfma_f32_16x16x32_bf16 v[64:67], v[196:199], v[168:171], v[64:67]
    v_exp_f32_e64 v225, v129
    v_mfma_f32_16x16x32_bf16 v[72:75], v[196:199], v[172:175], v[72:75]
    ds_read_b64_tr_b16 v[220:221], v15 offset:24576
    ds_read_b64_tr_b16 v[222:223], v15 offset:28672
    v_mfma_f32_16x16x32_bf16 v[144:147], v[200:203], v[40:43], v[144:147]
    v_exp_f32_e64 v226, v130
    v_mfma_f32_16x16x32_bf16 v[152:155], v[200:203], v[44:47], v[152:155]
    ds_read_b128 v[192:195], v8 offset:28672
    v_cvt_pk_bf16_f32 v160, v224, v225
    v_mfma_f32_16x16x32_bf16 v[68:71], v[204:207], v[168:171], v[68:71]
    v_exp_f32_e64 v227, v131
    v_mfma_f32_16x16x32_bf16 v[76:79], v[204:207], v[172:175], v[76:79]
    ds_read_b64_tr_b16 v[196:197], v16 offset:24576
    ds_read_b64_tr_b16 v[198:199], v16 offset:28672
    v_smfmac_f32_16x16x64_bf16 v[240:243], v[228:231], v[168:175], v244
    s_waitcnt lgkmcnt(3)
    v_mfma_f32_16x16x32_bf16 v[144:147], v[208:211], v[48:51], v[144:147]
    v_exp_f32 v224, v132
    v_mfma_f32_16x16x32_bf16 v[152:155], v[208:211], v[52:55], v[152:155]
    ds_read_b128 v[200:203], v9 offset:28672
    v_cvt_pk_bf16_f32 v161, v226, v227
    v_mfma_f32_16x16x32_bf16 v[80:83], v[212:215], v[168:171], v[80:83]
    v_exp_f32_e64 v225, v133
    v_mfma_f32_16x16x32_bf16 v[88:91], v[212:215], v[172:175], v[88:91]
    ds_read_b64_tr_b16 v[204:205], v17 offset:24576
    ds_read_b64_tr_b16 v[206:207], v17 offset:28672
    v_mfma_f32_16x16x32_bf16 v[144:147], v[216:219], v[56:59], v[144:147]
    v_exp_f32_e64 v226, v134
    v_mfma_f32_16x16x32_bf16 v[152:155], v[216:219], v[60:63], v[152:155]
    ds_read_b128 v[208:211], v10 offset:28672
    v_cvt_pk_bf16_f32 v162, v224, v225
    v_mfma_f32_16x16x32_bf16 v[84:87], v[220:223], v[168:171], v[84:87]
    v_exp_f32_e64 v227, v135
    v_mfma_f32_16x16x32_bf16 v[92:95], v[220:223], v[172:175], v[92:95]
    ds_read_b64_tr_b16 v[212:213], v18 offset:24576
    ds_read_b64_tr_b16 v[214:215], v18 offset:28672
    s_waitcnt lgkmcnt(3)
    v_mfma_f32_16x16x32_bf16 v[148:151], v[192:195], v[32:35], 0
    v_exp_f32 v224, v136
    v_mfma_f32_16x16x32_bf16 v[156:159], v[192:195], v[36:39], 0
    ds_read_b128 v[216:219], v11 offset:28672
    v_cvt_pk_bf16_f32 v163, v226, v227
    v_mfma_f32_16x16x32_bf16 v[96:99], v[196:199], v[168:171], v[96:99]
    v_exp_f32_e64 v225, v137
    v_mfma_f32_16x16x32_bf16 v[104:107], v[196:199], v[172:175], v[104:107]
    ds_read_b64_tr_b16 v[220:221], v19 offset:24576
    ds_read_b64_tr_b16 v[222:223], v19 offset:28672
    v_mfma_f32_16x16x32_bf16 v[148:151], v[200:203], v[40:43], v[148:151]
    v_exp_f32_e64 v226, v138
    v_mfma_f32_16x16x32_bf16 v[156:159], v[200:203], v[44:47], v[156:159]
    s_barrier
    ds_read_b128 v[192:195], v8 offset:32768
    v_cvt_pk_bf16_f32 v164, v224, v225
    v_mfma_f32_16x16x32_bf16 v[100:103], v[204:207], v[168:171], v[100:103]
    v_exp_f32 v227, v139
    v_mfma_f32_16x16x32_bf16 v[108:111], v[204:207], v[172:175], v[108:111]
    ds_read_b64_tr_b16 v[196:197], v12 offset:32768
    ds_read_b64_tr_b16 v[198:199], v12 offset:36864
    s_waitcnt lgkmcnt(3)
    v_mfma_f32_16x16x32_bf16 v[148:151], v[208:211], v[48:51], v[148:151]
    v_exp_f32 v224, v140
    v_mfma_f32_16x16x32_bf16 v[156:159], v[208:211], v[52:55], v[156:159]
    ds_read_b128 v[200:203], v9 offset:32768
    v_cvt_pk_bf16_f32 v165, v226, v227
    v_mfma_f32_16x16x32_bf16 v[112:115], v[212:215], v[168:171], v[112:115]
    v_exp_f32_e64 v225, v141
    v_mfma_f32_16x16x32_bf16 v[120:123], v[212:215], v[172:175], v[120:123]
    ds_read_b64_tr_b16 v[204:205], v13 offset:32768
    ds_read_b64_tr_b16 v[206:207], v13 offset:36864
    v_mfma_f32_16x16x32_bf16 v[148:151], v[216:219], v[56:59], v[148:151]
    v_exp_f32_e64 v226, v142
    v_mfma_f32_16x16x32_bf16 v[156:159], v[216:219], v[60:63], v[156:159]
    ds_read_b128 v[208:211], v10 offset:32768
    v_cvt_pk_bf16_f32 v166, v224, v225
    v_mfma_f32_16x16x32_bf16 v[116:119], v[220:223], v[168:171], v[116:119]
    v_exp_f32_e64 v227, v143
    v_mfma_f32_16x16x32_bf16 v[124:127], v[220:223], v[172:175], v[124:127]
    ds_read_b64_tr_b16 v[212:213], v14 offset:32768
    ds_read_b64_tr_b16 v[214:215], v14 offset:36864
    s_waitcnt lgkmcnt(3)
    v_mfma_f32_16x16x32_bf16 v[128:131], v[192:195], v[32:35], 0
    v_exp_f32 v224, v144
    v_mfma_f32_16x16x32_bf16 v[136:139], v[192:195], v[36:39], 0
    ds_read_b128 v[216:219], v11 offset:32768
    v_cvt_pk_bf16_f32 v167, v226, v227
    v_mfma_f32_16x16x32_bf16 v[64:67], v[196:199], v[160:163], v[64:67]
    v_exp_f32_e64 v225, v145
    v_mfma_f32_16x16x32_bf16 v[72:75], v[196:199], v[164:167], v[72:75]
    ds_read_b64_tr_b16 v[220:221], v15 offset:32768
    ds_read_b64_tr_b16 v[222:223], v15 offset:36864
    v_mfma_f32_16x16x32_bf16 v[128:131], v[200:203], v[40:43], v[128:131]
    v_exp_f32_e64 v226, v146
    v_mfma_f32_16x16x32_bf16 v[136:139], v[200:203], v[44:47], v[136:139]
    ds_read_b128 v[192:195], v8 offset:36864
    v_cvt_pk_bf16_f32 v168, v224, v225
    v_mfma_f32_16x16x32_bf16 v[68:71], v[204:207], v[160:163], v[68:71]
    v_exp_f32_e64 v227, v147
    v_mfma_f32_16x16x32_bf16 v[76:79], v[204:207], v[164:167], v[76:79]
    ds_read_b64_tr_b16 v[196:197], v16 offset:32768
    ds_read_b64_tr_b16 v[198:199], v16 offset:36864
    v_smfmac_f32_16x16x64_bf16 v[240:243], v[228:231], v[160:167], v244
    s_waitcnt lgkmcnt(3)
    v_mfma_f32_16x16x32_bf16 v[128:131], v[208:211], v[48:51], v[128:131]
    v_exp_f32 v224, v148
    v_mfma_f32_16x16x32_bf16 v[136:139], v[208:211], v[52:55], v[136:139]
    ds_read_b128 v[200:203], v9 offset:36864
    v_cvt_pk_bf16_f32 v169, v226, v227
    v_mfma_f32_16x16x32_bf16 v[80:83], v[212:215], v[160:163], v[80:83]
    v_exp_f32_e64 v225, v149
    v_mfma_f32_16x16x32_bf16 v[88:91], v[212:215], v[164:167], v[88:91]
    ds_read_b64_tr_b16 v[204:205], v17 offset:32768
    ds_read_b64_tr_b16 v[206:207], v17 offset:36864
    v_mfma_f32_16x16x32_bf16 v[128:131], v[216:219], v[56:59], v[128:131]
    v_exp_f32_e64 v226, v150
    v_mfma_f32_16x16x32_bf16 v[136:139], v[216:219], v[60:63], v[136:139]
    ds_read_b128 v[208:211], v10 offset:36864
    v_cvt_pk_bf16_f32 v170, v224, v225
    v_mfma_f32_16x16x32_bf16 v[84:87], v[220:223], v[160:163], v[84:87]
    v_exp_f32_e64 v227, v151
    v_mfma_f32_16x16x32_bf16 v[92:95], v[220:223], v[164:167], v[92:95]
    ds_read_b64_tr_b16 v[212:213], v18 offset:32768
    ds_read_b64_tr_b16 v[214:215], v18 offset:36864
    s_waitcnt lgkmcnt(3)
    v_mfma_f32_16x16x32_bf16 v[132:135], v[192:195], v[32:35], 0
    v_exp_f32 v224, v152
    v_mfma_f32_16x16x32_bf16 v[140:143], v[192:195], v[36:39], 0
    ds_read_b128 v[216:219], v11 offset:36864
    v_cvt_pk_bf16_f32 v171, v226, v227
    v_mfma_f32_16x16x32_bf16 v[96:99], v[196:199], v[160:163], v[96:99]
    v_exp_f32_e64 v225, v153
    v_mfma_f32_16x16x32_bf16 v[104:107], v[196:199], v[164:167], v[104:107]
    ds_read_b64_tr_b16 v[220:221], v19 offset:32768
    ds_read_b64_tr_b16 v[222:223], v19 offset:36864
    v_mfma_f32_16x16x32_bf16 v[132:135], v[200:203], v[40:43], v[132:135]
    v_exp_f32_e64 v226, v154
    v_mfma_f32_16x16x32_bf16 v[140:143], v[200:203], v[44:47], v[140:143]
    ds_read_b128 v[192:195], v8 offset:40960
    v_cvt_pk_bf16_f32 v172, v224, v225
    v_mfma_f32_16x16x32_bf16 v[100:103], v[204:207], v[160:163], v[100:103]
    v_exp_f32_e64 v227, v155
    v_mfma_f32_16x16x32_bf16 v[108:111], v[204:207], v[164:167], v[108:111]
    ds_read_b64_tr_b16 v[196:197], v12 offset:40960
    ds_read_b64_tr_b16 v[198:199], v12 offset:45056
    s_waitcnt lgkmcnt(3)
    v_mfma_f32_16x16x32_bf16 v[132:135], v[208:211], v[48:51], v[132:135]
    v_exp_f32 v224, v156
    v_mfma_f32_16x16x32_bf16 v[140:143], v[208:211], v[52:55], v[140:143]
    ds_read_b128 v[200:203], v9 offset:40960
    v_cvt_pk_bf16_f32 v173, v226, v227
    v_mfma_f32_16x16x32_bf16 v[112:115], v[212:215], v[160:163], v[112:115]
    v_exp_f32_e64 v225, v157
    v_mfma_f32_16x16x32_bf16 v[120:123], v[212:215], v[164:167], v[120:123]
    ds_read_b64_tr_b16 v[204:205], v13 offset:40960
    ds_read_b64_tr_b16 v[206:207], v13 offset:45056
    v_mfma_f32_16x16x32_bf16 v[132:135], v[216:219], v[56:59], v[132:135]
    v_exp_f32_e64 v226, v158
    v_mfma_f32_16x16x32_bf16 v[140:143], v[216:219], v[60:63], v[140:143]
    ds_read_b128 v[208:211], v10 offset:40960
    v_cvt_pk_bf16_f32 v174, v224, v225
    v_mfma_f32_16x16x32_bf16 v[116:119], v[220:223], v[160:163], v[116:119]
    v_exp_f32_e64 v227, v159
    v_mfma_f32_16x16x32_bf16 v[124:127], v[220:223], v[164:167], v[124:127]
    ds_read_b64_tr_b16 v[212:213], v14 offset:40960
    ds_read_b64_tr_b16 v[214:215], v14 offset:45056
    s_waitcnt lgkmcnt(3)
    v_mfma_f32_16x16x32_bf16 v[144:147], v[192:195], v[32:35], 0
    v_exp_f32 v224, v128
    v_mfma_f32_16x16x32_bf16 v[152:155], v[192:195], v[36:39], 0
    ds_read_b128 v[216:219], v11 offset:40960
    v_cvt_pk_bf16_f32 v175, v226, v227
    v_mfma_f32_16x16x32_bf16 v[64:67], v[196:199], v[168:171], v[64:67]
    v_exp_f32_e64 v225, v129
    v_mfma_f32_16x16x32_bf16 v[72:75], v[196:199], v[172:175], v[72:75]
    ds_read_b64_tr_b16 v[220:221], v15 offset:40960
    ds_read_b64_tr_b16 v[222:223], v15 offset:45056
    v_mfma_f32_16x16x32_bf16 v[144:147], v[200:203], v[40:43], v[144:147]
    v_exp_f32_e64 v226, v130
    v_mfma_f32_16x16x32_bf16 v[152:155], v[200:203], v[44:47], v[152:155]
    ds_read_b128 v[192:195], v8 offset:45056
    v_cvt_pk_bf16_f32 v160, v224, v225
    v_mfma_f32_16x16x32_bf16 v[68:71], v[204:207], v[168:171], v[68:71]
    v_exp_f32_e64 v227, v131
    v_mfma_f32_16x16x32_bf16 v[76:79], v[204:207], v[172:175], v[76:79]
    ds_read_b64_tr_b16 v[196:197], v16 offset:40960
    ds_read_b64_tr_b16 v[198:199], v16 offset:45056
    v_smfmac_f32_16x16x64_bf16 v[240:243], v[228:231], v[168:175], v244
    s_waitcnt lgkmcnt(3)
    v_mfma_f32_16x16x32_bf16 v[144:147], v[208:211], v[48:51], v[144:147]
    v_exp_f32 v224, v132
    v_mfma_f32_16x16x32_bf16 v[152:155], v[208:211], v[52:55], v[152:155]
    ds_read_b128 v[200:203], v9 offset:45056
    v_cvt_pk_bf16_f32 v161, v226, v227
    v_mfma_f32_16x16x32_bf16 v[80:83], v[212:215], v[168:171], v[80:83]
    v_exp_f32_e64 v225, v133
    v_mfma_f32_16x16x32_bf16 v[88:91], v[212:215], v[172:175], v[88:91]
    ds_read_b64_tr_b16 v[204:205], v17 offset:40960
    ds_read_b64_tr_b16 v[206:207], v17 offset:45056
    v_mfma_f32_16x16x32_bf16 v[144:147], v[216:219], v[56:59], v[144:147]
    v_exp_f32_e64 v226, v134
    v_mfma_f32_16x16x32_bf16 v[152:155], v[216:219], v[60:63], v[152:155]
    ds_read_b128 v[208:211], v10 offset:45056
    v_cvt_pk_bf16_f32 v162, v224, v225
    v_mfma_f32_16x16x32_bf16 v[84:87], v[220:223], v[168:171], v[84:87]
    v_exp_f32_e64 v227, v135
    v_mfma_f32_16x16x32_bf16 v[92:95], v[220:223], v[172:175], v[92:95]
    ds_read_b64_tr_b16 v[212:213], v18 offset:40960
    ds_read_b64_tr_b16 v[214:215], v18 offset:45056
    s_waitcnt lgkmcnt(3)
    v_mfma_f32_16x16x32_bf16 v[148:151], v[192:195], v[32:35], 0
    v_exp_f32 v224, v136
    v_mfma_f32_16x16x32_bf16 v[156:159], v[192:195], v[36:39], 0
    ds_read_b128 v[216:219], v11 offset:45056
    v_cvt_pk_bf16_f32 v163, v226, v227
    v_mfma_f32_16x16x32_bf16 v[96:99], v[196:199], v[168:171], v[96:99]
    v_exp_f32_e64 v225, v137
    v_mfma_f32_16x16x32_bf16 v[104:107], v[196:199], v[172:175], v[104:107]
    ds_read_b64_tr_b16 v[220:221], v19 offset:40960
    ds_read_b64_tr_b16 v[222:223], v19 offset:45056
L_pg2:
    s_cbranch_execz L_wret
    v_mfma_f32_16x16x32_bf16 v[148:151], v[200:203], v[40:43], v[148:151]
    v_exp_f32 v226, v138
    v_mfma_f32_16x16x32_bf16 v[156:159], v[200:203], v[44:47], v[156:159]
    s_barrier
    ds_read_b128 v[192:195], v8 offset:49152
    v_cvt_pk_bf16_f32 v164, v224, v225
    v_mfma_f32_16x16x32_bf16 v[100:103], v[204:207], v[168:171], v[100:103]
    v_exp_f32 v227, v139
    v_mfma_f32_16x16x32_bf16 v[108:111], v[204:207], v[172:175], v[108:111]
    ds_read_b64_tr_b16 v[196:197], v12 offset:49152
    ds_read_b64_tr_b16 v[198:199], v12 offset:53248
    s_waitcnt lgkmcnt(3)
    v_mfma_f32_16x16x32_bf16 v[148:151], v[208:211], v[48:51], v[148:151]
    v_exp_f32 v224, v140
    v_mfma_f32_16x16x32_bf16 v[156:159], v[208:211], v[52:55], v[156:159]
    ds_read_b128 v[200:203], v9 offset:49152
    v_cvt_pk_bf16_f32 v165, v226, v227
    v_mfma_f32_16x16x32_bf16 v[112:115], v[212:215], v[168:171], v[112:115]
    v_exp_f32_e64 v225, v141
    v_mfma_f32_16x16x32_bf16 v[120:123], v[212:215], v[172:175], v[120:123]
    ds_read_b64_tr_b16 v[204:205], v13 offset:49152
    ds_read_b64_tr_b16 v[206:207], v13 offset:53248
    v_mfma_f32_16x16x32_bf16 v[148:151], v[216:219], v[56:59], v[148:151]
    v_exp_f32_e64 v226, v142
    v_mfma_f32_16x16x32_bf16 v[156:159], v[216:219], v[60:63], v[156:159]
    ds_read_b128 v[208:211], v10 offset:49152
    v_cvt_pk_bf16_f32 v166, v224, v225
    v_mfma_f32_16x16x32_bf16 v[116:119], v[220:223], v[168:171], v[116:119]
    v_exp_f32_e64 v227, v143
    v_mfma_f32_16x16x32_bf16 v[124:127], v[220:223], v[172:175], v[124:127]
    ds_read_b64_tr_b16 v[212:213], v14 offset:49152
    ds_read_b64_tr_b16 v[214:215], v14 offset:53248
    s_waitcnt lgkmcnt(3)
    v_mfma_f32_16x16x32_bf16 v[128:131], v[192:195], v[32:35], 0
    v_exp_f32 v224, v144
    v_mfma_f32_16x16x32_bf16 v[136:139], v[192:195], v[36:39], 0
    ds_read_b128 v[216:219], v11 offset:49152
    v_cvt_pk_bf16_f32 v167, v226, v227
    v_mfma_f32_16x16x32_bf16 v[64:67], v[196:199], v[160:163], v[64:67]
    v_exp_f32_e64 v225, v145
    v_mfma_f32_16x16x32_bf16 v[72:75], v[196:199], v[164:167], v[72:75]
    ds_read_b64_tr_b16 v[220:221], v15 offset:49152
    ds_read_b64_tr_b16 v[222:223], v15 offset:53248
    v_mfma_f32_16x16x32_bf16 v[128:131], v[200:203], v[40:43], v[128:131]
    v_exp_f32_e64 v226, v146
    v_mfma_f32_16x16x32_bf16 v[136:139], v[200:203], v[44:47], v[136:139]
    ds_read_b128 v[192:195], v8 offset:53248
    v_cvt_pk_bf16_f32 v168, v224, v225
    v_mfma_f32_16x16x32_bf16 v[68:71], v[204:207], v[160:163], v[68:71]
    v_exp_f32_e64 v227, v147
    v_mfma_f32_16x16x32_bf16 v[76:79], v[204:207], v[164:167], v[76:79]
    ds_read_b64_tr_b16 v[196:197], v16 offset:49152
    ds_read_b64_tr_b16 v[198:199], v16 offset:53248
    v_smfmac_f32_16x16x64_bf16 v[240:243], v[228:231], v[160:167], v244
    s_waitcnt lgkmcnt(3)
    v_mfma_f32_16x16x32_bf16 v[128:131], v[208:211], v[48:51], v[128:131]
    v_exp_f32 v224, v148
    v_mfma_f32_16x16x32_bf16 v[136:139], v[208:211], v[52:55], v[136:139]
    ds_read_b128 v[200:203], v9 offset:53248
    v_cvt_pk_bf16_f32 v169, v226, v227
    v_mfma_f32_16x16x32_bf16 v[80:83], v[212:215], v[160:163], v[80:83]
    v_exp_f32_e64 v225, v149
    v_mfma_f32_16x16x32_bf16 v[88:91], v[212:215], v[164:167], v[88:91]
    ds_read_b64_tr_b16 v[204:205], v17 offset:49152
    ds_read_b64_tr_b16 v[206:207], v17 offset:53248
    v_mfma_f32_16x16x32_bf16 v[128:131], v[216:219], v[56:59], v[128:131]
    v_exp_f32_e64 v226, v150
    v_mfma_f32_16x16x32_bf16 v[136:139], v[216:219], v[60:63], v[136:139]
    ds_read_b128 v[208:211], v10 offset:53248
    v_cvt_pk_bf16_f32 v170, v224, v225
    v_mfma_f32_16x16x32_bf16 v[84:87], v[220:223], v[160:163], v[84:87]
    v_exp_f32_e64 v227, v151
    v_mfma_f32_16x16x32_bf16 v[92:95], v[220:223], v[164:167], v[92:95]
    ds_read_b64_tr_b16 v[212:213], v18 offset:49152
    ds_read_b64_tr_b16 v[214:215], v18 offset:53248
    s_waitcnt lgkmcnt(3)
    v_mfma_f32_16x16x32_bf16 v[132:135], v[192:195], v[32:35], 0
    v_exp_f32 v224, v152
    v_mfma_f32_16x16x32_bf16 v[140:143], v[192:195], v[36:39], 0
    ds_read_b128 v[216:219], v11 offset:53248
    v_cvt_pk_bf16_f32 v171, v226, v227
    v_mfma_f32_16x16x32_bf16 v[96:99], v[196:199], v[160:163], v[96:99]
    v_exp_f32_e64 v225, v153
    v_mfma_f32_16x16x32_bf16 v[104:107], v[196:199], v[164:167], v[104:107]
    ds_read_b64_tr_b16 v[220:221], v19 offset:49152
    ds_read_b64_tr_b16 v[222:223], v19 offset:53248
    v_mfma_f32_16x16x32_bf16 v[132:135], v[200:203], v[40:43], v[132:135]
    v_exp_f32_e64 v226, v154
    v_mfma_f32_16x16x32_bf16 v[140:143], v[200:203], v[44:47], v[140:143]
    ds_read_b128 v[192:195], v8 offset:57344
    v_cvt_pk_bf16_f32 v172, v224, v225
    v_mfma_f32_16x16x32_bf16 v[100:103], v[204:207], v[160:163], v[100:103]
    v_exp_f32_e64 v227, v155
    v_mfma_f32_16x16x32_bf16 v[108:111], v[204:207], v[164:167], v[108:111]
    ds_read_b64_tr_b16 v[196:197], v12 offset:57344
    ds_read_b64_tr_b16 v[198:199], v12 offset:61440
    s_waitcnt lgkmcnt(3)
    v_mfma_f32_16x16x32_bf16 v[132:135], v[208:211], v[48:51], v[132:135]
    v_exp_f32 v224, v156
    v_mfma_f32_16x16x32_bf16 v[140:143], v[208:211], v[52:55], v[140:143]
    ds_read_b128 v[200:203], v9 offset:57344
    v_cvt_pk_bf16_f32 v173, v226, v227
    v_mfma_f32_16x16x32_bf16 v[112:115], v[212:215], v[160:163], v[112:115]
    v_exp_f32_e64 v225, v157
    v_mfma_f32_16x16x32_bf16 v[120:123], v[212:215], v[164:167], v[120:123]
    ds_read_b64_tr_b16 v[204:205], v13 offset:57344
    ds_read_b64_tr_b16 v[206:207], v13 offset:61440
    v_mfma_f32_16x16x32_bf16 v[132:135], v[216:219], v[56:59], v[132:135]
    v_exp_f32_e64 v226, v158
    v_mfma_f32_16x16x32_bf16 v[140:143], v[216:219], v[60:63], v[140:143]
    ds_read_b128 v[208:211], v10 offset:57344
    v_cvt_pk_bf16_f32 v174, v224, v225
    v_mfma_f32_16x16x32_bf16 v[116:119], v[220:223], v[160:163], v[116:119]
    v_exp_f32_e64 v227, v159
    v_mfma_f32_16x16x32_bf16 v[124:127], v[220:223], v[164:167], v[124:127]
    ds_read_b64_tr_b16 v[212:213], v14 offset:57344
    ds_read_b64_tr_b16 v[214:215], v14 offset:61440
    s_waitcnt lgkmcnt(3)
    v_mfma_f32_16x16x32_bf16 v[144:147], v[192:195], v[32:35], 0
    v_exp_f32 v224, v128
    v_mfma_f32_16x16x32_bf16 v[152:155], v[192:195], v[36:39], 0
    ds_read_b128 v[216:219], v11 offset:57344
    v_cvt_pk_bf16_f32 v175, v226, v227
    v_mfma_f32_16x16x32_bf16 v[64:67], v[196:199], v[168:171], v[64:67]
    v_exp_f32_e64 v225, v129
    v_mfma_f32_16x16x32_bf16 v[72:75], v[196:199], v[172:175], v[72:75]
    ds_read_b64_tr_b16 v[220:221], v15 offset:57344
    ds_read_b64_tr_b16 v[222:223], v15 offset:61440
    v_mfma_f32_16x16x32_bf16 v[144:147], v[200:203], v[40:43], v[144:147]
    v_exp_f32_e64 v226, v130
    v_mfma_f32_16x16x32_bf16 v[152:155], v[200:203], v[44:47], v[152:155]
    ds_read_b128 v[192:195], v8 offset:61440
    v_cvt_pk_bf16_f32 v160, v224, v225
    v_mfma_f32_16x16x32_bf16 v[68:71], v[204:207], v[168:171], v[68:71]
    v_exp_f32_e64 v227, v131
    v_mfma_f32_16x16x32_bf16 v[76:79], v[204:207], v[172:175], v[76:79]
    ds_read_b64_tr_b16 v[196:197], v16 offset:57344
    ds_read_b64_tr_b16 v[198:199], v16 offset:61440
    v_smfmac_f32_16x16x64_bf16 v[240:243], v[228:231], v[168:175], v244
    s_waitcnt lgkmcnt(3)
    v_mfma_f32_16x16x32_bf16 v[144:147], v[208:211], v[48:51], v[144:147]
    v_exp_f32 v224, v132
    v_mfma_f32_16x16x32_bf16 v[152:155], v[208:211], v[52:55], v[152:155]
    ds_read_b128 v[200:203], v9 offset:61440
    v_cvt_pk_bf16_f32 v161, v226, v227
    v_mfma_f32_16x16x32_bf16 v[80:83], v[212:215], v[168:171], v[80:83]
    v_exp_f32_e64 v225, v133
    v_mfma_f32_16x16x32_bf16 v[88:91], v[212:215], v[172:175], v[88:91]
    ds_read_b64_tr_b16 v[204:205], v17 offset:57344
    ds_read_b64_tr_b16 v[206:207], v17 offset:61440
    v_mfma_f32_16x16x32_bf16 v[144:147], v[216:219], v[56:59], v[144:147]
    v_exp_f32_e64 v226, v134
    v_mfma_f32_16x16x32_bf16 v[152:155], v[216:219], v[60:63], v[152:155]
    ds_read_b128 v[208:211], v10 offset:61440
    v_cvt_pk_bf16_f32 v162, v224, v225
    v_mfma_f32_16x16x32_bf16 v[84:87], v[220:223], v[168:171], v[84:87]
    v_exp_f32_e64 v227, v135
    v_mfma_f32_16x16x32_bf16 v[92:95], v[220:223], v[172:175], v[92:95]
    ds_read_b64_tr_b16 v[212:213], v18 offset:57344
    ds_read_b64_tr_b16 v[214:215], v18 offset:61440
    s_waitcnt lgkmcnt(3)
    v_mfma_f32_16x16x32_bf16 v[148:151], v[192:195], v[32:35], 0
    v_exp_f32 v224, v136
    v_mfma_f32_16x16x32_bf16 v[156:159], v[192:195], v[36:39], 0
    ds_read_b128 v[216:219], v11 offset:61440
    v_cvt_pk_bf16_f32 v163, v226, v227
    v_mfma_f32_16x16x32_bf16 v[96:99], v[196:199], v[168:171], v[96:99]
    v_exp_f32_e64 v225, v137
    v_mfma_f32_16x16x32_bf16 v[104:107], v[196:199], v[172:175], v[104:107]
    ds_read_b64_tr_b16 v[220:221], v19 offset:57344
    ds_read_b64_tr_b16 v[222:223], v19 offset:61440
    v_mfma_f32_16x16x32_bf16 v[148:151], v[200:203], v[40:43], v[148:151]
    v_exp_f32_e64 v226, v138
    v_mfma_f32_16x16x32_bf16 v[156:159], v[200:203], v[44:47], v[156:159]
    s_barrier
    ds_read_b128 v[192:195], v8 offset:0
    v_cvt_pk_bf16_f32 v164, v224, v225
    v_mfma_f32_16x16x32_bf16 v[100:103], v[204:207], v[168:171], v[100:103]
    v_exp_f32 v227, v139
    v_mfma_f32_16x16x32_bf16 v[108:111], v[204:207], v[172:175], v[108:111]
    ds_read_b64_tr_b16 v[196:197], v12 offset:0
    ds_read_b64_tr_b16 v[198:199], v12 offset:4096
    s_waitcnt lgkmcnt(3)
    v_mfma_f32_16x16x32_bf16 v[148:151], v[208:211], v[48:51], v[148:151]
    v_exp_f32 v224, v140
    v_mfma_f32_16x16x32_bf16 v[156:159], v[208:211], v[52:55], v[156:159]
    ds_read_b128 v[200:203], v9 offset:0
    v_cvt_pk_bf16_f32 v165, v226, v227
    v_mfma_f32_16x16x32_bf16 v[112:115], v[212:215], v[168:171], v[112:115]
    v_exp_f32_e64 v225, v141
    v_mfma_f32_16x16x32_bf16 v[120:123], v[212:215], v[172:175], v[120:123]
    ds_read_b64_tr_b16 v[204:205], v13 offset:0
    ds_read_b64_tr_b16 v[206:207], v13 offset:4096
    v_mfma_f32_16x16x32_bf16 v[148:151], v[216:219], v[56:59], v[148:151]
    v_exp_f32_e64 v226, v142
    v_mfma_f32_16x16x32_bf16 v[156:159], v[216:219], v[60:63], v[156:159]
    ds_read_b128 v[208:211], v10 offset:0
    v_cvt_pk_bf16_f32 v166, v224, v225
    v_mfma_f32_16x16x32_bf16 v[116:119], v[220:223], v[168:171], v[116:119]
    v_exp_f32_e64 v227, v143
    v_mfma_f32_16x16x32_bf16 v[124:127], v[220:223], v[172:175], v[124:127]
    ds_read_b64_tr_b16 v[212:213], v14 offset:0
    ds_read_b64_tr_b16 v[214:215], v14 offset:4096
    s_waitcnt lgkmcnt(3)
    v_mfma_f32_16x16x32_bf16 v[128:131], v[192:195], v[32:35], 0
    v_exp_f32 v224, v144
    v_mfma_f32_16x16x32_bf16 v[136:139], v[192:195], v[36:39], 0
    ds_read_b128 v[216:219], v11 offset:0
    v_cvt_pk_bf16_f32 v167, v226, v227
    v_mfma_f32_16x16x32_bf16 v[64:67], v[196:199], v[160:163], v[64:67]
    v_exp_f32_e64 v225, v145
    v_mfma_f32_16x16x32_bf16 v[72:75], v[196:199], v[164:167], v[72:75]
    ds_read_b64_tr_b16 v[220:221], v15 offset:0
    ds_read_b64_tr_b16 v[222:223], v15 offset:4096
    v_mfma_f32_16x16x32_bf16 v[128:131], v[200:203], v[40:43], v[128:131]
    v_exp_f32_e64 v226, v146
    v_mfma_f32_16x16x32_bf16 v[136:139], v[200:203], v[44:47], v[136:139]
    ds_read_b128 v[192:195], v8 offset:4096
    v_cvt_pk_bf16_f32 v168, v224, v225
    v_mfma_f32_16x16x32_bf16 v[68:71], v[204:207], v[160:163], v[68:71]
    v_exp_f32_e64 v227, v147
    v_mfma_f32_16x16x32_bf16 v[76:79], v[204:207], v[164:167], v[76:79]
    ds_read_b64_tr_b16 v[196:197], v16 offset:0
    ds_read_b64_tr_b16 v[198:199], v16 offset:4096
    v_smfmac_f32_16x16x64_bf16 v[240:243], v[228:231], v[160:167], v244
    s_waitcnt lgkmcnt(3)
    v_mfma_f32_16x16x32_bf16 v[128:131], v[208:211], v[48:51], v[128:131]
    v_exp_f32 v224, v148
    v_mfma_f32_16x16x32_bf16 v[136:139], v[208:211], v[52:55], v[136:139]
    ds_read_b128 v[200:203], v9 offset:4096
    v_cvt_pk_bf16_f32 v169, v226, v227
    v_mfma_f32_16x16x32_bf16 v[80:83], v[212:215], v[160:163], v[80:83]
    v_exp_f32_e64 v225, v149
    v_mfma_f32_16x16x32_bf16 v[88:91], v[212:215], v[164:167], v[88:91]
    ds_read_b64_tr_b16 v[204:205], v17 offset:0
    ds_read_b64_tr_b16 v[206:207], v17 offset:4096
    v_mfma_f32_16x16x32_bf16 v[128:131], v[216:219], v[56:59], v[128:131]
    v_exp_f32_e64 v226, v150
    v_mfma_f32_16x16x32_bf16 v[136:139], v[216:219], v[60:63], v[136:139]
    ds_read_b128 v[208:211], v10 offset:4096
    v_cvt_pk_bf16_f32 v170, v224, v225
    v_mfma_f32_16x16x32_bf16 v[84:87], v[220:223], v[160:163], v[84:87]
    v_exp_f32_e64 v227, v151
    v_mfma_f32_16x16x32_bf16 v[92:95], v[220:223], v[164:167], v[92:95]
    ds_read_b64_tr_b16 v[212:213], v18 offset:0
    ds_read_b64_tr_b16 v[214:215], v18 offset:4096
    s_waitcnt lgkmcnt(3)
    v_mfma_f32_16x16x32_bf16 v[132:135], v[192:195], v[32:35], 0
    v_exp_f32 v224, v152
    v_mfma_f32_16x16x32_bf16 v[140:143], v[192:195], v[36:39], 0
    ds_read_b128 v[216:219], v11 offset:4096
    v_cvt_pk_bf16_f32 v171, v226, v227
    v_mfma_f32_16x16x32_bf16 v[96:99], v[196:199], v[160:163], v[96:99]
    v_exp_f32_e64 v225, v153
    v_mfma_f32_16x16x32_bf16 v[104:107], v[196:199], v[164:167], v[104:107]
    ds_read_b64_tr_b16 v[220:221], v19 offset:0
    ds_read_b64_tr_b16 v[222:223], v19 offset:4096
    v_mfma_f32_16x16x32_bf16 v[132:135], v[200:203], v[40:43], v[132:135]
    v_exp_f32_e64 v226, v154
    v_mfma_f32_16x16x32_bf16 v[140:143], v[200:203], v[44:47], v[140:143]
    ds_read_b128 v[192:195], v8 offset:8192
    v_cvt_pk_bf16_f32 v172, v224, v225
    v_mfma_f32_16x16x32_bf16 v[100:103], v[204:207], v[160:163], v[100:103]
    v_exp_f32_e64 v227, v155
    v_mfma_f32_16x16x32_bf16 v[108:111], v[204:207], v[164:167], v[108:111]
    ds_read_b64_tr_b16 v[196:197], v12 offset:8192
    ds_read_b64_tr_b16 v[198:199], v12 offset:12288
    s_waitcnt lgkmcnt(3)
    v_mfma_f32_16x16x32_bf16 v[132:135], v[208:211], v[48:51], v[132:135]
    v_exp_f32 v224, v156
    v_mfma_f32_16x16x32_bf16 v[140:143], v[208:211], v[52:55], v[140:143]
    ds_read_b128 v[200:203], v9 offset:8192
    v_cvt_pk_bf16_f32 v173, v226, v227
    v_mfma_f32_16x16x32_bf16 v[112:115], v[212:215], v[160:163], v[112:115]
    v_exp_f32_e64 v225, v157
    v_mfma_f32_16x16x32_bf16 v[120:123], v[212:215], v[164:167], v[120:123]
    ds_read_b64_tr_b16 v[204:205], v13 offset:8192
    ds_read_b64_tr_b16 v[206:207], v13 offset:12288
    v_mfma_f32_16x16x32_bf16 v[132:135], v[216:219], v[56:59], v[132:135]
    v_exp_f32_e64 v226, v158
    v_mfma_f32_16x16x32_bf16 v[140:143], v[216:219], v[60:63], v[140:143]
    ds_read_b128 v[208:211], v10 offset:8192
    v_cvt_pk_bf16_f32 v174, v224, v225
    v_mfma_f32_16x16x32_bf16 v[116:119], v[220:223], v[160:163], v[116:119]
    v_exp_f32_e64 v227, v159
    v_mfma_f32_16x16x32_bf16 v[124:127], v[220:223], v[164:167], v[124:127]
    ds_read_b64_tr_b16 v[212:213], v14 offset:8192
    ds_read_b64_tr_b16 v[214:215], v14 offset:12288
    s_waitcnt lgkmcnt(3)
    v_mfma_f32_16x16x32_bf16 v[144:147], v[192:195], v[32:35], 0
    v_exp_f32 v224, v128
    v_mfma_f32_16x16x32_bf16 v[152:155], v[192:195], v[36:39], 0
    ds_read_b128 v[216:219], v11 offset:8192
    v_cvt_pk_bf16_f32 v175, v226, v227
    v_mfma_f32_16x16x32_bf16 v[64:67], v[196:199], v[168:171], v[64:67]
    v_exp_f32_e64 v225, v129
    v_mfma_f32_16x16x32_bf16 v[72:75], v[196:199], v[172:175], v[72:75]
    ds_read_b64_tr_b16 v[220:221], v15 offset:8192
    ds_read_b64_tr_b16 v[222:223], v15 offset:12288
    v_mfma_f32_16x16x32_bf16 v[144:147], v[200:203], v[40:43], v[144:147]
    v_exp_f32_e64 v226, v130
    v_mfma_f32_16x16x32_bf16 v[152:155], v[200:203], v[44:47], v[152:155]
    ds_read_b128 v[192:195], v8 offset:12288
    v_cvt_pk_bf16_f32 v160, v224, v225
    v_mfma_f32_16x16x32_bf16 v[68:71], v[204:207], v[168:171], v[68:71]
    v_exp_f32_e64 v227, v131
    v_mfma_f32_16x16x32_bf16 v[76:79], v[204:207], v[172:175], v[76:79]
    ds_read_b64_tr_b16 v[196:197], v16 offset:8192
    ds_read_b64_tr_b16 v[198:199], v16 offset:12288
    v_smfmac_f32_16x16x64_bf16 v[240:243], v[228:231], v[168:175], v244
    s_waitcnt lgkmcnt(3)
    v_mfma_f32_16x16x32_bf16 v[144:147], v[208:211], v[48:51], v[144:147]
    v_exp_f32 v224, v132
    v_mfma_f32_16x16x32_bf16 v[152:155], v[208:211], v[52:55], v[152:155]
    ds_read_b128 v[200:203], v9 offset:12288
    v_cvt_pk_bf16_f32 v161, v226, v227
    v_mfma_f32_16x16x32_bf16 v[80:83], v[212:215], v[168:171], v[80:83]
    v_exp_f32_e64 v225, v133
    v_mfma_f32_16x16x32_bf16 v[88:91], v[212:215], v[172:175], v[88:91]
    ds_read_b64_tr_b16 v[204:205], v17 offset:8192
    ds_read_b64_tr_b16 v[206:207], v17 offset:12288
    v_mfma_f32_16x16x32_bf16 v[144:147], v[216:219], v[56:59], v[144:147]
    v_exp_f32_e64 v226, v134
    v_mfma_f32_16x16x32_bf16 v[152:155], v[216:219], v[60:63], v[152:155]
    ds_read_b128 v[208:211], v10 offset:12288
    v_cvt_pk_bf16_f32 v162, v224, v225
    v_mfma_f32_16x16x32_bf16 v[84:87], v[220:223], v[168:171], v[84:87]
    v_exp_f32_e64 v227, v135
    v_mfma_f32_16x16x32_bf16 v[92:95], v[220:223], v[172:175], v[92:95]
    ds_read_b64_tr_b16 v[212:213], v18 offset:8192
    ds_read_b64_tr_b16 v[214:215], v18 offset:12288
    s_waitcnt lgkmcnt(3)
    v_mfma_f32_16x16x32_bf16 v[148:151], v[192:195], v[32:35], 0
    v_exp_f32 v224, v136
    v_mfma_f32_16x16x32_bf16 v[156:159], v[192:195], v[36:39], 0
    ds_read_b128 v[216:219], v11 offset:12288
    v_cvt_pk_bf16_f32 v163, v226, v227
    v_mfma_f32_16x16x32_bf16 v[96:99], v[196:199], v[168:171], v[96:99]
    v_exp_f32_e64 v225, v137
    v_mfma_f32_16x16x32_bf16 v[104:107], v[196:199], v[172:175], v[104:107]
    ds_read_b64_tr_b16 v[220:221], v19 offset:8192
    ds_read_b64_tr_b16 v[222:223], v19 offset:12288
    v_mfma_f32_16x16x32_bf16 v[148:151], v[200:203], v[40:43], v[148:151]
    v_exp_f32_e64 v226, v138
    v_mfma_f32_16x16x32_bf16 v[156:159], v[200:203], v[44:47], v[156:159]
    s_barrier
    ds_read_b128 v[192:195], v8 offset:16384
    v_cvt_pk_bf16_f32 v164, v224, v225
    v_mfma_f32_16x16x32_bf16 v[100:103], v[204:207], v[168:171], v[100:103]
    v_exp_f32 v227, v139
    v_mfma_f32_16x16x32_bf16 v[108:111], v[204:207], v[172:175], v[108:111]
    ds_read_b64_tr_b16 v[196:197], v12 offset:16384
    ds_read_b64_tr_b16 v[198:199], v12 offset:20480
    s_waitcnt lgkmcnt(3)
    v_mfma_f32_16x16x32_bf16 v[148:151], v[208:211], v[48:51], v[148:151]
    v_exp_f32 v224, v140
    v_mfma_f32_16x16x32_bf16 v[156:159], v[208:211], v[52:55], v[156:159]
    ds_read_b128 v[200:203], v9 offset:16384
    v_cvt_pk_bf16_f32 v165, v226, v227
    s_add_u32 s49, s49, 1
    v_mfma_f32_16x16x32_bf16 v[112:115], v[212:215], v[168:171], v[112:115]
    v_exp_f32 v225, v141
    v_mfma_f32_16x16x32_bf16 v[120:123], v[212:215], v[172:175], v[120:123]
    ds_read_b64_tr_b16 v[204:205], v13 offset:16384
    ds_read_b64_tr_b16 v[206:207], v13 offset:20480
    v_mfma_f32_16x16x32_bf16 v[148:151], v[216:219], v[56:59], v[148:151]
    v_exp_f32_e64 v226, v142
    v_mfma_f32_16x16x32_bf16 v[156:159], v[216:219], v[60:63], v[156:159]
    ds_read_b128 v[208:211], v10 offset:16384
    v_cvt_pk_bf16_f32 v166, v224, v225
    s_cmp_lt_u32 s49, 3
    v_mfma_f32_16x16x32_bf16 v[116:119], v[220:223], v[168:171], v[116:119]
    v_exp_f32 v227, v143
    v_mfma_f32_16x16x32_bf16 v[124:127], v[220:223], v[172:175], v[124:127]
    ds_read_b64_tr_b16 v[212:213], v14 offset:16384
    ds_read_b64_tr_b16 v[214:215], v14 offset:20480
    s_cbranch_scc1 L2_cloop
    s_waitcnt lgkmcnt(3)
    v_mfma_f32_16x16x32_bf16 v[128:131], v[192:195], v[32:35], 0
    v_exp_f32_e64 v224, v144
    v_mfma_f32_16x16x32_bf16 v[136:139], v[192:195], v[36:39], 0
    ds_read_b128 v[216:219], v11 offset:16384
    v_cvt_pk_bf16_f32 v167, v226, v227
    v_mfma_f32_16x16x32_bf16 v[64:67], v[196:199], v[160:163], v[64:67]
    v_exp_f32_e64 v225, v145
    v_mfma_f32_16x16x32_bf16 v[72:75], v[196:199], v[164:167], v[72:75]
    ds_read_b64_tr_b16 v[220:221], v15 offset:16384
    ds_read_b64_tr_b16 v[222:223], v15 offset:20480
    v_mfma_f32_16x16x32_bf16 v[128:131], v[200:203], v[40:43], v[128:131]
    v_exp_f32_e64 v226, v146
    v_mfma_f32_16x16x32_bf16 v[136:139], v[200:203], v[44:47], v[136:139]
    ds_read_b128 v[192:195], v8 offset:20480
    v_cvt_pk_bf16_f32 v168, v224, v225
    v_mfma_f32_16x16x32_bf16 v[68:71], v[204:207], v[160:163], v[68:71]
    v_exp_f32_e64 v227, v147
    v_mfma_f32_16x16x32_bf16 v[76:79], v[204:207], v[164:167], v[76:79]
    ds_read_b64_tr_b16 v[196:197], v16 offset:16384
    ds_read_b64_tr_b16 v[198:199], v16 offset:20480
    v_smfmac_f32_16x16x64_bf16 v[240:243], v[228:231], v[160:167], v244
    s_waitcnt lgkmcnt(3)
    v_mfma_f32_16x16x32_bf16 v[128:131], v[208:211], v[48:51], v[128:131]
    v_exp_f32 v224, v148
    v_mfma_f32_16x16x32_bf16 v[136:139], v[208:211], v[52:55], v[136:139]
    ds_read_b128 v[200:203], v9 offset:20480
    v_cvt_pk_bf16_f32 v169, v226, v227
    v_mfma_f32_16x16x32_bf16 v[80:83], v[212:215], v[160:163], v[80:83]
    v_exp_f32_e64 v225, v149
    v_mfma_f32_16x16x32_bf16 v[88:91], v[212:215], v[164:167], v[88:91]
    ds_read_b64_tr_b16 v[204:205], v17 offset:16384
    ds_read_b64_tr_b16 v[206:207], v17 offset:20480
    v_mfma_f32_16x16x32_bf16 v[128:131], v[216:219], v[56:59], v[128:131]
    v_exp_f32_e64 v226, v150
    v_mfma_f32_16x16x32_bf16 v[136:139], v[216:219], v[60:63], v[136:139]
    ds_read_b128 v[208:211], v10 offset:20480
    v_cvt_pk_bf16_f32 v170, v224, v225
    v_mfma_f32_16x16x32_bf16 v[84:87], v[220:223], v[160:163], v[84:87]
    v_exp_f32_e64 v227, v151
    v_mfma_f32_16x16x32_bf16 v[92:95], v[220:223], v[164:167], v[92:95]
    ds_read_b64_tr_b16 v[212:213], v18 offset:16384
    ds_read_b64_tr_b16 v[214:215], v18 offset:20480
    s_waitcnt lgkmcnt(3)
    v_mfma_f32_16x16x32_bf16 v[132:135], v[192:195], v[32:35], 0
    v_exp_f32 v224, v152
    v_mfma_f32_16x16x32_bf16 v[140:143], v[192:195], v[36:39], 0
    ds_read_b128 v[216:219], v11 offset:20480
    v_cvt_pk_bf16_f32 v171, v226, v227
    v_mfma_f32_16x16x32_bf16 v[96:99], v[196:199], v[160:163], v[96:99]
    v_exp_f32_e64 v225, v153
    v_mfma_f32_16x16x32_bf16 v[104:107], v[196:199], v[164:167], v[104:107]
    ds_read_b64_tr_b16 v[220:221], v19 offset:16384
    ds_read_b64_tr_b16 v[222:223], v19 offset:20480
    v_mfma_f32_16x16x32_bf16 v[132:135], v[200:203], v[40:43], v[132:135]
    v_exp_f32_e64 v226, v154
    v_mfma_f32_16x16x32_bf16 v[140:143], v[200:203], v[44:47], v[140:143]
    ds_read_b128 v[192:195], v8 offset:24576
    v_cvt_pk_bf16_f32 v172, v224, v225
    v_mfma_f32_16x16x32_bf16 v[100:103], v[204:207], v[160:163], v[100:103]
    v_exp_f32_e64 v227, v155
    v_mfma_f32_16x16x32_bf16 v[108:111], v[204:207], v[164:167], v[108:111]
    ds_read_b64_tr_b16 v[196:197], v12 offset:24576
    ds_read_b64_tr_b16 v[198:199], v12 offset:28672
    s_waitcnt lgkmcnt(3)
    v_mfma_f32_16x16x32_bf16 v[132:135], v[208:211], v[48:51], v[132:135]
    v_exp_f32 v224, v156
    v_mfma_f32_16x16x32_bf16 v[140:143], v[208:211], v[52:55], v[140:143]
    ds_read_b128 v[200:203], v9 offset:24576
    v_cvt_pk_bf16_f32 v173, v226, v227
    v_mfma_f32_16x16x32_bf16 v[112:115], v[212:215], v[160:163], v[112:115]
    v_exp_f32_e64 v225, v157
    v_mfma_f32_16x16x32_bf16 v[120:123], v[212:215], v[164:167], v[120:123]
    ds_read_b64_tr_b16 v[204:205], v13 offset:24576
    ds_read_b64_tr_b16 v[206:207], v13 offset:28672
    v_mfma_f32_16x16x32_bf16 v[132:135], v[216:219], v[56:59], v[132:135]
    v_exp_f32_e64 v226, v158
    v_mfma_f32_16x16x32_bf16 v[140:143], v[216:219], v[60:63], v[140:143]
    ds_read_b128 v[208:211], v10 offset:24576
    v_cvt_pk_bf16_f32 v174, v224, v225
    v_mfma_f32_16x16x32_bf16 v[116:119], v[220:223], v[160:163], v[116:119]
    v_exp_f32_e64 v227, v159
    v_mfma_f32_16x16x32_bf16 v[124:127], v[220:223], v[164:167], v[124:127]
    ds_read_b64_tr_b16 v[212:213], v14 offset:24576
    ds_read_b64_tr_b16 v[214:215], v14 offset:28672
    s_waitcnt lgkmcnt(3)
    v_mfma_f32_16x16x32_bf16 v[144:147], v[192:195], v[32:35], 0
    v_exp_f32 v224, v128
    v_mfma_f32_16x16x32_bf16 v[152:155], v[192:195], v[36:39], 0
    ds_read_b128 v[216:219], v11 offset:24576
    v_cvt_pk_bf16_f32 v175, v226, v227
    v_mfma_f32_16x16x32_bf16 v[64:67], v[196:199], v[168:171], v[64:67]
    v_exp_f32_e64 v225, v129
    v_mfma_f32_16x16x32_bf16 v[72:75], v[196:199], v[172:175], v[72:75]
    ds_read_b64_tr_b16 v[220:221], v15 offset:24576
    ds_read_b64_tr_b16 v[222:223], v15 offset:28672
    buffer_store_dword v6, v5, s[12:15], s87 offen sc1
    v_mfma_f32_16x16x32_bf16 v[144:147], v[200:203], v[40:43], v[144:147]
    v_exp_f32_e64 v226, v130
    v_mfma_f32_16x16x32_bf16 v[152:155], v[200:203], v[44:47], v[152:155]
    ds_read_b128 v[192:195], v8 offset:28672
    v_cvt_pk_bf16_f32 v160, v224, v225
    v_mfma_f32_16x16x32_bf16 v[68:71], v[204:207], v[168:171], v[68:71]
    v_exp_f32_e64 v227, v131
    v_mfma_f32_16x16x32_bf16 v[76:79], v[204:207], v[172:175], v[76:79]
    ds_read_b64_tr_b16 v[196:197], v16 offset:24576
    ds_read_b64_tr_b16 v[198:199], v16 offset:28672
    v_smfmac_f32_16x16x64_bf16 v[240:243], v[228:231], v[168:175], v244
    s_waitcnt lgkmcnt(3)
    v_mfma_f32_16x16x32_bf16 v[144:147], v[208:211], v[48:51], v[144:147]
    v_exp_f32 v224, v132
    v_mfma_f32_16x16x32_bf16 v[152:155], v[208:211], v[52:55], v[152:155]
    ds_read_b128 v[200:203], v9 offset:28672
    v_cvt_pk_bf16_f32 v161, v226, v227
    v_mfma_f32_16x16x32_bf16 v[80:83], v[212:215], v[168:171], v[80:83]
    v_exp_f32_e64 v225, v133
    v_mfma_f32_16x16x32_bf16 v[88:91], v[212:215], v[172:175], v[88:91]
    ds_read_b64_tr_b16 v[204:205], v17 offset:24576
    ds_read_b64_tr_b16 v[206:207], v17 offset:28672
    v_mfma_f32_16x16x32_bf16 v[144:147], v[216:219], v[56:59], v[144:147]
    v_exp_f32_e64 v226, v134
    v_mfma_f32_16x16x32_bf16 v[152:155], v[216:219], v[60:63], v[152:155]
    ds_read_b128 v[208:211], v10 offset:28672
    v_cvt_pk_bf16_f32 v162, v224, v225
    v_mfma_f32_16x16x32_bf16 v[84:87], v[220:223], v[168:171], v[84:87]
    v_exp_f32_e64 v227, v135
    v_mfma_f32_16x16x32_bf16 v[92:95], v[220:223], v[172:175], v[92:95]
    ds_read_b64_tr_b16 v[212:213], v18 offset:24576
    ds_read_b64_tr_b16 v[214:215], v18 offset:28672
    s_waitcnt lgkmcnt(3)
    v_mfma_f32_16x16x32_bf16 v[148:151], v[192:195], v[32:35], 0
    v_exp_f32 v224, v136
    v_mfma_f32_16x16x32_bf16 v[156:159], v[192:195], v[36:39], 0
    ds_read_b128 v[216:219], v11 offset:28672
    v_cvt_pk_bf16_f32 v163, v226, v227
    v_mfma_f32_16x16x32_bf16 v[96:99], v[196:199], v[168:171], v[96:99]
    v_exp_f32_e64 v225, v137
    v_mfma_f32_16x16x32_bf16 v[104:107], v[196:199], v[172:175], v[104:107]
    ds_read_b64_tr_b16 v[220:221], v19 offset:24576
    ds_read_b64_tr_b16 v[222:223], v19 offset:28672
    v_mfma_f32_16x16x32_bf16 v[148:151], v[200:203], v[40:43], v[148:151]
    v_exp_f32_e64 v226, v138
    v_mfma_f32_16x16x32_bf16 v[156:159], v[200:203], v[44:47], v[156:159]
    s_barrier
    ds_read_b128 v[192:195], v8 offset:32768
    v_cvt_pk_bf16_f32 v164, v224, v225
    v_mfma_f32_16x16x32_bf16 v[100:103], v[204:207], v[168:171], v[100:103]
    v_exp_f32 v227, v139
    v_mfma_f32_16x16x32_bf16 v[108:111], v[204:207], v[172:175], v[108:111]
    ds_read_b64_tr_b16 v[196:197], v12 offset:32768
    ds_read_b64_tr_b16 v[198:199], v12 offset:36864
    s_waitcnt lgkmcnt(3)
    v_mfma_f32_16x16x32_bf16 v[148:151], v[208:211], v[48:51], v[148:151]
    v_exp_f32 v224, v140
    v_mfma_f32_16x16x32_bf16 v[156:159], v[208:211], v[52:55], v[156:159]
    ds_read_b128 v[200:203], v9 offset:32768
    v_cvt_pk_bf16_f32 v165, v226, v227
    v_mfma_f32_16x16x32_bf16 v[112:115], v[212:215], v[168:171], v[112:115]
    v_exp_f32_e64 v225, v141
    v_mfma_f32_16x16x32_bf16 v[120:123], v[212:215], v[172:175], v[120:123]
    ds_read_b64_tr_b16 v[204:205], v13 offset:32768
    ds_read_b64_tr_b16 v[206:207], v13 offset:36864
    v_mfma_f32_16x16x32_bf16 v[148:151], v[216:219], v[56:59], v[148:151]
    v_exp_f32_e64 v226, v142
    v_mfma_f32_16x16x32_bf16 v[156:159], v[216:219], v[60:63], v[156:159]
    ds_read_b128 v[208:211], v10 offset:32768
L_pg3:
    s_cbranch_execz L_wret
    v_cvt_pk_bf16_f32 v166, v224, v225
    v_mfma_f32_16x16x32_bf16 v[116:119], v[220:223], v[168:171], v[116:119]
    v_exp_f32 v227, v143
    v_mfma_f32_16x16x32_bf16 v[124:127], v[220:223], v[172:175], v[124:127]
    ds_read_b64_tr_b16 v[212:213], v14 offset:32768
    ds_read_b64_tr_b16 v[214:215], v14 offset:36864
    s_waitcnt lgkmcnt(3)
    v_mfma_f32_16x16x32_bf16 v[128:131], v[192:195], v[32:35], 0
    v_exp_f32 v224, v144
    v_mfma_f32_16x16x32_bf16 v[136:139], v[192:195], v[36:39], 0
    ds_read_b128 v[216:219], v11 offset:32768
    v_cvt_pk_bf16_f32 v167, v226, v227
    v_mfma_f32_16x16x32_bf16 v[64:67], v[196:199], v[160:163], v[64:67]
    v_exp_f32_e64 v225, v145
    v_mfma_f32_16x16x32_bf16 v[72:75], v[196:199], v[164:167], v[72:75]
    ds_read_b64_tr_b16 v[220:221], v15 offset:32768
    ds_read_b64_tr_b16 v[222:223], v15 offset:36864
    v_mfma_f32_16x16x32_bf16 v[128:131], v[200:203], v[40:43], v[128:131]
    v_exp_f32_e64 v226, v146
    v_mfma_f32_16x16x32_bf16 v[136:139], v[200:203], v[44:47], v[136:139]
    ds_read_b128 v[192:195], v8 offset:36864
    v_cvt_pk_bf16_f32 v168, v224, v225
    v_mfma_f32_16x16x32_bf16 v[68:71], v[204:207], v[160:163], v[68:71]
    v_exp_f32_e64 v227, v147
    v_mfma_f32_16x16x32_bf16 v[76:79], v[204:207], v[164:167], v[76:79]
    ds_read_b64_tr_b16 v[196:197], v16 offset:32768
    ds_read_b64_tr_b16 v[198:199], v16 offset:36864
    v_smfmac_f32_16x16x64_bf16 v[240:243], v[228:231], v[160:167], v244
    s_waitcnt lgkmcnt(3)
    v_mfma_f32_16x16x32_bf16 v[128:131], v[208:211], v[48:51], v[128:131]
    v_exp_f32 v224, v148
    v_mfma_f32_16x16x32_bf16 v[136:139], v[208:211], v[52:55], v[136:139]
    ds_read_b128 v[200:203], v9 offset:36864
    v_cvt_pk_bf16_f32 v169, v226, v227
    v_mfma_f32_16x16x32_bf16 v[80:83], v[212:215], v[160:163], v[80:83]
    v_exp_f32_e64 v225, v149
    v_mfma_f32_16x16x32_bf16 v[88:91], v[212:215], v[164:167], v[88:91]
    ds_read_b64_tr_b16 v[204:205], v17 offset:32768
    ds_read_b64_tr_b16 v[206:207], v17 offset:36864
    v_mfma_f32_16x16x32_bf16 v[128:131], v[216:219], v[56:59], v[128:131]
    v_exp_f32_e64 v226, v150
    v_mfma_f32_16x16x32_bf16 v[136:139], v[216:219], v[60:63], v[136:139]
    ds_read_b128 v[208:211], v10 offset:36864
    v_cvt_pk_bf16_f32 v170, v224, v225
    v_mfma_f32_16x16x32_bf16 v[84:87], v[220:223], v[160:163], v[84:87]
    v_exp_f32_e64 v227, v151
    v_mfma_f32_16x16x32_bf16 v[92:95], v[220:223], v[164:167], v[92:95]
    ds_read_b64_tr_b16 v[212:213], v18 offset:32768
    ds_read_b64_tr_b16 v[214:215], v18 offset:36864
    s_waitcnt lgkmcnt(3)
    v_mfma_f32_16x16x32_bf16 v[132:135], v[192:195], v[32:35], 0
    v_exp_f32 v224, v152
    v_mfma_f32_16x16x32_bf16 v[140:143], v[192:195], v[36:39], 0
    ds_read_b128 v[216:219], v11 offset:36864
    v_cvt_pk_bf16_f32 v171, v226, v227
    v_mfma_f32_16x16x32_bf16 v[96:99], v[196:199], v[160:163], v[96:99]
    v_exp_f32_e64 v225, v153
    v_mfma_f32_16x16x32_bf16 v[104:107], v[196:199], v[164:167], v[104:107]
    ds_read_b64_tr_b16 v[220:221], v19 offset:32768
    ds_read_b64_tr_b16 v[222:223], v19 offset:36864
    v_mfma_f32_16x16x32_bf16 v[132:135], v[200:203], v[40:43], v[132:135]
    v_exp_f32_e64 v226, v154
    v_mfma_f32_16x16x32_bf16 v[140:143], v[200:203], v[44:47], v[140:143]
    ds_read_b128 v[192:195], v8 offset:40960
    v_cvt_pk_bf16_f32 v172, v224, v225
    v_mfma_f32_16x16x32_bf16 v[100:103], v[204:207], v[160:163], v[100:103]
    v_exp_f32_e64 v227, v155
    v_mfma_f32_16x16x32_bf16 v[108:111], v[204:207], v[164:167], v[108:111]
    ds_read_b64_tr_b16 v[196:197], v12 offset:40960
    ds_read_b64_tr_b16 v[198:199], v12 offset:45056
    s_waitcnt lgkmcnt(3)
    v_mfma_f32_16x16x32_bf16 v[132:135], v[208:211], v[48:51], v[132:135]
    v_exp_f32 v224, v156
    v_mfma_f32_16x16x32_bf16 v[140:143], v[208:211], v[52:55], v[140:143]
    ds_read_b128 v[200:203], v9 offset:40960
    v_cvt_pk_bf16_f32 v173, v226, v227
    v_mfma_f32_16x16x32_bf16 v[112:115], v[212:215], v[160:163], v[112:115]
    v_exp_f32_e64 v225, v157
    v_mfma_f32_16x16x32_bf16 v[120:123], v[212:215], v[164:167], v[120:123]
    ds_read_b64_tr_b16 v[204:205], v13 offset:40960
    ds_read_b64_tr_b16 v[206:207], v13 offset:45056
    v_mfma_f32_16x16x32_bf16 v[132:135], v[216:219], v[56:59], v[132:135]
    v_exp_f32_e64 v226, v158
    v_mfma_f32_16x16x32_bf16 v[140:143], v[216:219], v[60:63], v[140:143]
    ds_read_b128 v[208:211], v10 offset:40960
    v_cvt_pk_bf16_f32 v174, v224, v225
    v_mfma_f32_16x16x32_bf16 v[116:119], v[220:223], v[160:163], v[116:119]
    v_exp_f32_e64 v227, v159
    v_mfma_f32_16x16x32_bf16 v[124:127], v[220:223], v[164:167], v[124:127]
    ds_read_b64_tr_b16 v[212:213], v14 offset:40960
    ds_read_b64_tr_b16 v[214:215], v14 offset:45056
    s_waitcnt lgkmcnt(3)
    v_mfma_f32_16x16x32_bf16 v[144:147], v[192:195], v[32:35], 0
    v_exp_f32 v224, v128
    v_mfma_f32_16x16x32_bf16 v[152:155], v[192:195], v[36:39], 0
    ds_read_b128 v[216:219], v11 offset:40960
    v_cvt_pk_bf16_f32 v175, v226, v227
    v_mfma_f32_16x16x32_bf16 v[64:67], v[196:199], v[168:171], v[64:67]
    v_exp_f32_e64 v225, v129
    v_mfma_f32_16x16x32_bf16 v[72:75], v[196:199], v[172:175], v[72:75]
    ds_read_b64_tr_b16 v[220:221], v15 offset:40960
    ds_read_b64_tr_b16 v[222:223], v15 offset:45056
    v_mfma_f32_16x16x32_bf16 v[144:147], v[200:203], v[40:43], v[144:147]
    v_exp_f32_e64 v226, v130
    v_mfma_f32_16x16x32_bf16 v[152:155], v[200:203], v[44:47], v[152:155]
    ds_read_b128 v[192:195], v8 offset:45056
    v_cvt_pk_bf16_f32 v160, v224, v225
    v_mfma_f32_16x16x32_bf16 v[68:71], v[204:207], v[168:171], v[68:71]
    v_exp_f32_e64 v227, v131
    v_mfma_f32_16x16x32_bf16 v[76:79], v[204:207], v[172:175], v[76:79]
    ds_read_b64_tr_b16 v[196:197], v16 offset:40960
    ds_read_b64_tr_b16 v[198:199], v16 offset:45056
    v_smfmac_f32_16x16x64_bf16 v[240:243], v[228:231], v[168:175], v244
    s_waitcnt lgkmcnt(3)
    v_mfma_f32_16x16x32_bf16 v[144:147], v[208:211], v[48:51], v[144:147]
    v_exp_f32 v224, v132
    v_mfma_f32_16x16x32_bf16 v[152:155], v[208:211], v[52:55], v[152:155]
    ds_read_b128 v[200:203], v9 offset:45056
    v_cvt_pk_bf16_f32 v161, v226, v227
    v_mfma_f32_16x16x32_bf16 v[80:83], v[212:215], v[168:171], v[80:83]
    v_exp_f32_e64 v225, v133
    v_mfma_f32_16x16x32_bf16 v[88:91], v[212:215], v[172:175], v[88:91]
    ds_read_b64_tr_b16 v[204:205], v17 offset:40960
    ds_read_b64_tr_b16 v[206:207], v17 offset:45056
    v_mfma_f32_16x16x32_bf16 v[144:147], v[216:219], v[56:59], v[144:147]
    v_exp_f32_e64 v226, v134
    v_mfma_f32_16x16x32_bf16 v[152:155], v[216:219], v[60:63], v[152:155]
    ds_read_b128 v[208:211], v10 offset:45056
    v_cvt_pk_bf16_f32 v162, v224, v225
    v_mfma_f32_16x16x32_bf16 v[84:87], v[220:223], v[168:171], v[84:87]
    v_exp_f32_e64 v227, v135
    v_mfma_f32_16x16x32_bf16 v[92:95], v[220:223], v[172:175], v[92:95]
    ds_read_b64_tr_b16 v[212:213], v18 offset:40960
    ds_read_b64_tr_b16 v[214:215], v18 offset:45056
    s_waitcnt lgkmcnt(3)
    v_mfma_f32_16x16x32_bf16 v[148:151], v[192:195], v[32:35], 0
    v_exp_f32 v224, v136
    v_mfma_f32_16x16x32_bf16 v[156:159], v[192:195], v[36:39], 0
    ds_read_b128 v[216:219], v11 offset:45056
    v_cvt_pk_bf16_f32 v163, v226, v227
    v_mfma_f32_16x16x32_bf16 v[96:99], v[196:199], v[168:171], v[96:99]
    v_exp_f32_e64 v225, v137
    v_mfma_f32_16x16x32_bf16 v[104:107], v[196:199], v[172:175], v[104:107]
    ds_read_b64_tr_b16 v[220:221], v19 offset:40960
    ds_read_b64_tr_b16 v[222:223], v19 offset:45056
    v_mfma_f32_16x16x32_bf16 v[148:151], v[200:203], v[40:43], v[148:151]
    v_exp_f32_e64 v226, v138
    v_mfma_f32_16x16x32_bf16 v[156:159], v[200:203], v[44:47], v[156:159]
    s_barrier
    ds_read_b128 v[192:195], v8 offset:49152
    v_cvt_pk_bf16_f32 v164, v224, v225
    v_mfma_f32_16x16x32_bf16 v[100:103], v[204:207], v[168:171], v[100:103]
    v_exp_f32 v227, v139
    v_mfma_f32_16x16x32_bf16 v[108:111], v[204:207], v[172:175], v[108:111]
    ds_read_b128 v[196:199], v9 offset:49152
    s_waitcnt lgkmcnt(2)
    v_mfma_f32_16x16x32_bf16 v[148:151], v[208:211], v[48:51], v[148:151]
    v_exp_f32 v224, v140
    v_mfma_f32_16x16x32_bf16 v[156:159], v[208:211], v[52:55], v[156:159]
    ds_read_b128 v[200:203], v10 offset:49152
    v_cvt_pk_bf16_f32 v165, v226, v227
    v_mfma_f32_16x16x32_bf16 v[112:115], v[212:215], v[168:171], v[112:115]
    v_exp_f32_e64 v225, v141
    v_mfma_f32_16x16x32_bf16 v[120:123], v[212:215], v[172:175], v[120:123]
    ds_read_b128 v[204:207], v11 offset:49152
    v_mfma_f32_16x16x32_bf16 v[148:151], v[216:219], v[56:59], v[148:151]
    v_exp_f32_e64 v226, v142
    v_mfma_f32_16x16x32_bf16 v[156:159], v[216:219], v[60:63], v[156:159]
    ds_read_b128 v[208:211], v8 offset:53248
    v_cvt_pk_bf16_f32 v166, v224, v225
    v_mfma_f32_16x16x32_bf16 v[116:119], v[220:223], v[168:171], v[116:119]
    v_exp_f32_e64 v227, v143
    v_mfma_f32_16x16x32_bf16 v[124:127], v[220:223], v[172:175], v[124:127]
    ds_read_b128 v[212:215], v9 offset:53248
    s_waitcnt lgkmcnt(2)
    v_mfma_f32_16x16x32_bf16 v[128:131], v[192:195], v[32:35], 0
    v_exp_f32 v224, v144
    v_cvt_pk_bf16_f32 v167, v226, v227
    v_mfma_f32_16x16x32_bf16 v[136:139], v[192:195], v[36:39], 0
    ds_read_b128 v[216:219], v10 offset:53248
    v_exp_f32_e64 v225, v145
    v_mfma_f32_16x16x32_bf16 v[128:131], v[196:199], v[40:43], v[128:131]
    v_exp_f32_e64 v226, v146
    v_cvt_pk_bf16_f32 v168, v224, v225
    v_mfma_f32_16x16x32_bf16 v[136:139], v[196:199], v[44:47], v[136:139]
    ds_read_b128 v[220:223], v11 offset:53248
    v_exp_f32_e64 v227, v147
    v_mfma_f32_16x16x32_bf16 v[128:131], v[200:203], v[48:51], v[128:131]
    v_exp_f32_e64 v224, v148
    v_cvt_pk_bf16_f32 v169, v226, v227
    v_mfma_f32_16x16x32_bf16 v[136:139], v[200:203], v[52:55], v[136:139]
    ds_read_b128 v[192:195], v8 offset:57344
    v_exp_f32_e64 v225, v149
    v_mfma_f32_16x16x32_bf16 v[128:131], v[204:207], v[56:59], v[128:131]
    v_exp_f32_e64 v226, v150
    v_cvt_pk_bf16_f32 v170, v224, v225
    v_mfma_f32_16x16x32_bf16 v[136:139], v[204:207], v[60:63], v[136:139]
    ds_read_b128 v[196:199], v9 offset:57344
    v_exp_f32 v227, v151
    s_waitcnt lgkmcnt(2)
    v_mfma_f32_16x16x32_bf16 v[132:135], v[208:211], v[32:35], 0
    v_exp_f32_e64 v224, v152
    v_cvt_pk_bf16_f32 v171, v226, v227
    v_mfma_f32_16x16x32_bf16 v[140:143], v[208:211], v[36:39], 0
    ds_read_b128 v[200:203], v10 offset:57344
    v_exp_f32_e64 v225, v153
    v_mfma_f32_16x16x32_bf16 v[132:135], v[212:215], v[40:43], v[132:135]
    v_exp_f32_e64 v226, v154
    v_cvt_pk_bf16_f32 v172, v224, v225
    v_mfma_f32_16x16x32_bf16 v[140:143], v[212:215], v[44:47], v[140:143]
    ds_read_b128 v[204:207], v11 offset:57344
    v_exp_f32_e64 v227, v155
    v_smfmac_f32_16x16x64_bf16 v[240:243], v[228:231], v[160:167], v244
    v_mfma_f32_16x16x32_bf16 v[132:135], v[216:219], v[48:51], v[132:135]
    v_exp_f32_e64 v224, v156
    v_cvt_pk_bf16_f32 v173, v226, v227
    v_mfma_f32_16x16x32_bf16 v[140:143], v[216:219], v[52:55], v[140:143]
    ds_read_b128 v[208:211], v8 offset:61440
    v_exp_f32_e64 v225, v157
    v_mfma_f32_16x16x32_bf16 v[132:135], v[220:223], v[56:59], v[132:135]
    v_exp_f32_e64 v226, v158
    v_cvt_pk_bf16_f32 v174, v224, v225
    v_mfma_f32_16x16x32_bf16 v[140:143], v[220:223], v[60:63], v[140:143]
    ds_read_b128 v[212:215], v9 offset:61440
    v_exp_f32 v227, v159
    s_waitcnt lgkmcnt(2)
    v_mfma_f32_16x16x32_bf16 v[144:147], v[192:195], v[32:35], 0
    v_exp_f32_e64 v224, v128
    v_cvt_pk_bf16_f32 v175, v226, v227
    v_mfma_f32_16x16x32_bf16 v[152:155], v[192:195], v[36:39], 0
    ds_read_b128 v[216:219], v10 offset:61440
    v_exp_f32_e64 v225, v129
    v_mfma_f32_16x16x32_bf16 v[144:147], v[196:199], v[40:43], v[144:147]
    v_exp_f32_e64 v226, v130
    v_cvt_pk_bf16_f32 v176, v224, v225
    v_mfma_f32_16x16x32_bf16 v[152:155], v[196:199], v[44:47], v[152:155]
    ds_read_b128 v[220:223], v11 offset:61440
    v_exp_f32_e64 v227, v131
    v_mfma_f32_16x16x32_bf16 v[144:147], v[200:203], v[48:51], v[144:147]
    v_exp_f32_e64 v224, v132
    v_cvt_pk_bf16_f32 v177, v226, v227
    v_mfma_f32_16x16x32_bf16 v[152:155], v[200:203], v[52:55], v[152:155]
    ds_read_b64_tr_b16 v[192:193], v12 offset:49152
    ds_read_b64_tr_b16 v[194:195], v12 offset:53248
    v_exp_f32_e64 v225, v133
    v_mfma_f32_16x16x32_bf16 v[144:147], v[204:207], v[56:59], v[144:147]
    v_exp_f32_e64 v226, v134
    v_cvt_pk_bf16_f32 v178, v224, v225
    v_mfma_f32_16x16x32_bf16 v[152:155], v[204:207], v[60:63], v[152:155]
    ds_read_b64_tr_b16 v[196:197], v13 offset:49152
    ds_read_b64_tr_b16 v[198:199], v13 offset:53248
    v_exp_f32 v227, v135
    s_waitcnt lgkmcnt(4)
    v_mfma_f32_16x16x32_bf16 v[148:151], v[208:211], v[32:35], 0
    v_exp_f32_e64 v224, v136
    v_cvt_pk_bf16_f32 v179, v226, v227
    v_mfma_f32_16x16x32_bf16 v[156:159], v[208:211], v[36:39], 0
    ds_read_b64_tr_b16 v[200:201], v12 offset:57344
    ds_read_b64_tr_b16 v[202:203], v12 offset:61440
    v_exp_f32_e64 v225, v137
    v_mfma_f32_16x16x32_bf16 v[148:151], v[212:215], v[40:43], v[148:151]
    v_exp_f32_e64 v226, v138
    v_cvt_pk_bf16_f32 v180, v224, v225
    v_mfma_f32_16x16x32_bf16 v[156:159], v[212:215], v[44:47], v[156:159]
    ds_read_b64_tr_b16 v[204:205], v13 offset:57344
    ds_read_b64_tr_b16 v[206:207], v13 offset:61440
    v_exp_f32_e64 v227, v139
    v_smfmac_f32_16x16x64_bf16 v[240:243], v[228:231], v[168:175], v244
    v_mfma_f32_16x16x32_bf16 v[148:151], v[216:219], v[48:51], v[148:151]
    v_exp_f32_e64 v224, v140
    v_cvt_pk_bf16_f32 v181, v226, v227
    v_mfma_f32_16x16x32_bf16 v[156:159], v[216:219], v[52:55], v[156:159]
    ds_read_b64_tr_b16 v[208:209], v14 offset:49152
    ds_read_b64_tr_b16 v[210:211], v14 offset:53248
    v_exp_f32_e64 v225, v141
    v_mfma_f32_16x16x32_bf16 v[148:151], v[220:223], v[56:59], v[148:151]
    v_exp_f32_e64 v226, v142
    v_cvt_pk_bf16_f32 v182, v224, v225
    v_mfma_f32_16x16x32_bf16 v[156:159], v[220:223], v[60:63], v[156:159]
    ds_read_b64_tr_b16 v[212:213], v15 offset:49152
    ds_read_b64_tr_b16 v[214:215], v15 offset:53248
    v_exp_f32 v227, v143
    s_nop 0
    v_cvt_pk_bf16_f32 v183, v226, v227
    s_waitcnt lgkmcnt(4)
    v_mfma_f32_16x16x32_bf16 v[64:67], v[192:195], v[160:163], v[64:67]
    v_exp_f32 v224, v144
    v_mfma_f32_16x16x32_bf16 v[72:75], v[192:195], v[164:167], v[72:75]
    ds_read_b64_tr_b16 v[216:217], v14 offset:57344
    ds_read_b64_tr_b16 v[218:219], v14 offset:61440
    v_exp_f32_e64 v225, v145
    v_mfma_f32_16x16x32_bf16 v[68:71], v[196:199], v[160:163], v[68:71]
    v_exp_f32_e64 v226, v146
    v_cvt_pk_bf16_f32 v184, v224, v225
    v_mfma_f32_16x16x32_bf16 v[76:79], v[196:199], v[164:167], v[76:79]
    ds_read_b64_tr_b16 v[220:221], v15 offset:57344
    ds_read_b64_tr_b16 v[222:223], v15 offset:61440
    v_exp_f32_e64 v227, v147
    v_mfma_f32_16x16x32_bf16 v[64:67], v[200:203], v[168:171], v[64:67]
    v_exp_f32_e64 v224, v148
    v_cvt_pk_bf16_f32 v185, v226, v227
    v_mfma_f32_16x16x32_bf16 v[72:75], v[200:203], v[172:175], v[72:75]
    s_barrier
    ds_read_b64_tr_b16 v[192:193], v12 offset:0
    ds_read_b64_tr_b16 v[194:195], v12 offset:4096
    v_exp_f32 v225, v149
    v_mfma_f32_16x16x32_bf16 v[68:71], v[204:207], v[168:171], v[68:71]
    v_exp_f32_e64 v226, v150
    v_cvt_pk_bf16_f32 v186, v224, v225
    v_mfma_f32_16x16x32_bf16 v[76:79], v[204:207], v[172:175], v[76:79]
    ds_read_b64_tr_b16 v[196:197], v13 offset:0
    ds_read_b64_tr_b16 v[198:199], v13 offset:4096
    v_exp_f32 v227, v151
    s_waitcnt lgkmcnt(4)
    v_mfma_f32_16x16x32_bf16 v[80:83], v[208:211], v[160:163], v[80:83]
    v_exp_f32_e64 v224, v152
    v_cvt_pk_bf16_f32 v187, v226, v227
    v_mfma_f32_16x16x32_bf16 v[88:91], v[208:211], v[164:167], v[88:91]
    ds_read_b64_tr_b16 v[200:201], v12 offset:8192
    ds_read_b64_tr_b16 v[202:203], v12 offset:12288
    v_exp_f32_e64 v225, v153
    v_mfma_f32_16x16x32_bf16 v[84:87], v[212:215], v[160:163], v[84:87]
    v_exp_f32_e64 v226, v154
    v_cvt_pk_bf16_f32 v188, v224, v225
    v_mfma_f32_16x16x32_bf16 v[92:95], v[212:215], v[164:167], v[92:95]
    ds_read_b64_tr_b16 v[204:205], v13 offset:8192
    ds_read_b64_tr_b16 v[206:207], v13 offset:12288
    v_exp_f32_e64 v227, v155
    v_smfmac_f32_16x16x64_bf16 v[240:243], v[228:231], v[176:183], v244
    v_mfma_f32_16x16x32_bf16 v[80:83], v[216:219], v[168:171], v[80:83]
    v_exp_f32_e64 v224, v156
    v_cvt_pk_bf16_f32 v189, v226, v227
    v_mfma_f32_16x16x32_bf16 v[88:91], v[216:219], v[172:175], v[88:91]
    ds_read_b64_tr_b16 v[208:209], v14 offset:0
    ds_read_b64_tr_b16 v[210:211], v14 offset:4096
    v_exp_f32_e64 v225, v157
    v_mfma_f32_16x16x32_bf16 v[84:87], v[220:223], v[168:171], v[84:87]
    v_exp_f32_e64 v226, v158
    v_cvt_pk_bf16_f32 v190, v224, v225
    v_mfma_f32_16x16x32_bf16 v[92:95], v[220:223], v[172:175], v[92:95]
    ds_read_b64_tr_b16 v[212:213], v15 offset:0
    ds_read_b64_tr_b16 v[214:215], v15 offset:4096
    v_exp_f32 v227, v159
    s_nop 0
    v_cvt_pk_bf16_f32 v191, v226, v227
    s_nop 1
    v_smfmac_f32_16x16x64_bf16 v[240:243], v[228:231], v[184:191], v244
    s_waitcnt lgkmcnt(4)
    v_mfma_f32_16x16x32_bf16 v[64:67], v[192:195], v[176:179], v[64:67]
    v_mfma_f32_16x16x32_bf16 v[72:75], v[192:195], v[180:183], v[72:75]
    ds_read_b64_tr_b16 v[216:217], v14 offset:8192
    ds_read_b64_tr_b16 v[218:219], v14 offset:12288
    v_mfma_f32_16x16x32_bf16 v[68:71], v[196:199], v[176:179], v[68:71]
    v_mfma_f32_16x16x32_bf16 v[76:79], v[196:199], v[180:183], v[76:79]
    ds_read_b64_tr_b16 v[220:221], v15 offset:8192
    ds_read_b64_tr_b16 v[222:223], v15 offset:12288
    s_nop 2
    v_add_f32 v240, v240, v241
    v_add_f32 v244, v242, v243
    v_min_f32 v30, v240, v244
    v_max_f32 v31, v240, v244
    v_rcp_f32 v28, v240
    v_rcp_f32_e64 v29, v244
    v_cmp_nlt_f32 vcc, 0x2b800000, v30
    s_nop 0
    s_mov_b64 s[42:43], vcc
    v_cmp_ngt_f32 vcc, 0x53800000, v31
    s_nop 0
    s_or_b64 s[42:43], vcc, s[42:43]
    v_cmp_u_f32 vcc, v240, v244
    v_mfma_f32_16x16x32_bf16 v[64:67], v[200:203], v[184:187], v[64:67]
    v_mfma_f32_16x16x32_bf16 v[72:75], v[200:203], v[188:191], v[72:75]
    ds_read_b64_tr_b16 v[192:193], v16 offset:49152
    ds_read_b64_tr_b16 v[194:195], v16 offset:53248
    s_or_b64 vcc, vcc, s[42:43]
    v_mfma_f32_16x16x32_bf16 v[68:71], v[204:207], v[184:187], v[68:71]
    v_mfma_f32_16x16x32_bf16 v[76:79], v[204:207], v[188:191], v[76:79]
    ds_read_b64_tr_b16 v[196:197], v17 offset:49152
    ds_read_b64_tr_b16 v[198:199], v17 offset:53248
    s_cbranch_vccnz L_fb
    s_waitcnt lgkmcnt(4)
    v_mfma_f32_16x16x32_bf16 v[80:83], v[208:211], v[176:179], v[80:83]
    v_mfma_f32_16x16x32_bf16 v[88:91], v[208:211], v[180:183], v[88:91]
    ds_read_b64_tr_b16 v[200:201], v16 offset:57344
    ds_read_b64_tr_b16 v[202:203], v16 offset:61440
    v_mfma_f32_16x16x32_bf16 v[84:87], v[212:215], v[176:179], v[84:87]
    v_mul_f32 v64, v64, v28
    v_mul_f32 v65, v65, v28
    v_mul_f32_e64 v66, v66, v28
    v_mfma_f32_16x16x32_bf16 v[92:95], v[212:215], v[180:183], v[92:95]
    ds_read_b64_tr_b16 v[204:205], v17 offset:57344
    ds_read_b64_tr_b16 v[206:207], v17 offset:61440
    v_mul_f32 v67, v67, v28
    v_mul_f32 v68, v68, v28
    v_mul_f32_e64 v69, v69, v28
    v_mfma_f32_16x16x32_bf16 v[80:83], v[216:219], v[184:187], v[80:83]
    v_mul_f32 v70, v70, v28
    v_mul_f32 v71, v71, v28
    v_cvt_pk_bf16_f32 v64, v64, v65
    v_mfma_f32_16x16x32_bf16 v[88:91], v[216:219], v[188:191], v[88:91]
    ds_read_b64_tr_b16 v[208:209], v16 offset:0
    ds_read_b64_tr_b16 v[210:211], v16 offset:4096
    v_cvt_pk_bf16_f32 v65, v66, v67
    v_cvt_pk_bf16_f32 v66, v68, v69
    v_cvt_pk_bf16_f32 v67, v70, v71
    v_mfma_f32_16x16x32_bf16 v[84:87], v[220:223], v[184:187], v[84:87]
    buffer_store_dwordx4 v[64:67], v1, s[12:15], s54 offen offset:0
    v_mul_f32 v72, v72, v29
    v_mul_f32 v73, v73, v29
    v_mfma_f32_16x16x32_bf16 v[92:95], v[220:223], v[188:191], v[92:95]
    ds_read_b64_tr_b16 v[212:213], v17 offset:0
    ds_read_b64_tr_b16 v[214:215], v17 offset:4096
    v_mul_f32 v74, v74, v29
    v_mul_f32 v75, v75, v29
    v_mul_f32 v76, v76, v29
    s_waitcnt lgkmcnt(4)
    v_mfma_f32_16x16x32_bf16 v[96:99], v[192:195], v[160:163], v[96:99]
    v_mul_f32 v77, v77, v29
    v_mul_f32 v78, v78, v29
    v_mul_f32_e64 v79, v79, v29
    v_mfma_f32_16x16x32_bf16 v[104:107], v[192:195], v[164:167], v[104:107]
    ds_read_b64_tr_b16 v[216:217], v16 offset:8192
    ds_read_b64_tr_b16 v[218:219], v16 offset:12288
    v_cvt_pk_bf16_f32 v72, v72, v73
    v_cvt_pk_bf16_f32 v73, v74, v75
    v_cvt_pk_bf16_f32 v74, v76, v77
    v_mfma_f32_16x16x32_bf16 v[100:103], v[196:199], v[160:163], v[100:103]
    v_cvt_pk_bf16_f32 v75, v78, v79
    buffer_store_dwordx4 v[72:75], v1, s[12:15], s54 offen offset:1024
    v_mul_f32_e64 v80, v80, v28
    v_mfma_f32_16x16x32_bf16 v[108:111], v[196:199], v[164:167], v[108:111]
    ds_read_b64_tr_b16 v[220:221], v17 offset:8192
    ds_read_b64_tr_b16 v[222:223], v17 offset:12288
    v_mul_f32 v81, v81, v28
    v_mul_f32 v82, v82, v28
    v_mul_f32_e64 v83, v83, v28
    v_mfma_f32_16x16x32_bf16 v[96:99], v[200:203], v[168:171], v[96:99]
    v_mul_f32 v84, v84, v28
    v_mul_f32 v85, v85, v28
    v_mul_f32_e64 v86, v86, v28
    v_mfma_f32_16x16x32_bf16 v[104:107], v[200:203], v[172:175], v[104:107]
    ds_read_b64_tr_b16 v[192:193], v18 offset:49152
    ds_read_b64_tr_b16 v[194:195], v18 offset:53248
    v_mul_f32_e64 v87, v87, v28
    v_cvt_pk_bf16_f32 v80, v80, v81
    v_cvt_pk_bf16_f32 v81, v82, v83
    v_mfma_f32_16x16x32_bf16 v[100:103], v[204:207], v[168:171], v[100:103]
    v_cvt_pk_bf16_f32 v82, v84, v85
    v_cvt_pk_bf16_f32 v83, v86, v87
    buffer_store_dwordx4 v[80:83], v1, s[12:15], s54 offen offset:2048
    v_mfma_f32_16x16x32_bf16 v[108:111], v[204:207], v[172:175], v[108:111]
    ds_read_b64_tr_b16 v[196:197], v19 offset:49152
    ds_read_b64_tr_b16 v[198:199], v19 offset:53248
    v_mul_f32 v88, v88, v29
    v_mul_f32 v89, v89, v29
    v_mul_f32 v90, v90, v29
    s_waitcnt lgkmcnt(4)
    v_mfma_f32_16x16x32_bf16 v[96:99], v[208:211], v[176:179], v[96:99]
    v_mul_f32 v91, v91, v29
    v_mul_f32 v92, v92, v29
    v_mul_f32_e64 v93, v93, v29
    v_mfma_f32_16x16x32_bf16 v[104:107], v[208:211], v[180:183], v[104:107]
    ds_read_b64_tr_b16 v[200:201], v18 offset:57344
    ds_read_b64_tr_b16 v[202:203], v18 offset:61440
    v_mul_f32 v94, v94, v29
    v_mul_f32 v95, v95, v29
    v_cvt_pk_bf16_f32 v88, v88, v89
    v_mfma_f32_16x16x32_bf16 v[100:103], v[212:215], v[176:179], v[100:103]
    v_cvt_pk_bf16_f32 v89, v90, v91
    v_cvt_pk_bf16_f32 v90, v92, v93
    v_cvt_pk_bf16_f32 v91, v94, v95
    v_mfma_f32_16x16x32_bf16 v[108:111], v[212:215], v[180:183], v[108:111]
    ds_read_b64_tr_b16 v[204:205], v19 offset:57344
    ds_read_b64_tr_b16 v[206:207], v19 offset:61440
    buffer_store_dwordx4 v[88:91], v1, s[12:15], s54 offen offset:3072
    v_mfma_f32_16x16x32_bf16 v[96:99], v[216:219], v[184:187], v[96:99]
    v_mfma_f32_16x16x32_bf16 v[104:107], v[216:219], v[188:191], v[104:107]
    ds_read_b64_tr_b16 v[208:209], v18 offset:0
    ds_read_b64_tr_b16 v[210:211], v18 offset:4096
    v_mfma_f32_16x16x32_bf16 v[100:103], v[220:223], v[184:187], v[100:103]
    v_mfma_f32_16x16x32_bf16 v[108:111], v[220:223], v[188:191], v[108:111]
    ds_read_b64_tr_b16 v[212:213], v19 offset:0
    ds_read_b64_tr_b16 v[214:215], v19 offset:4096
    s_waitcnt lgkmcnt(4)
    v_mfma_f32_16x16x32_bf16 v[112:115], v[192:195], v[160:163], v[112:115]
    v_mfma_f32_16x16x32_bf16 v[120:123], v[192:195], v[164:167], v[120:123]
    ds_read_b64_tr_b16 v[216:217], v18 offset:8192
    ds_read_b64_tr_b16 v[218:219], v18 offset:12288
    v_mfma_f32_16x16x32_bf16 v[116:119], v[196:199], v[160:163], v[116:119]
    v_mul_f32 v96, v96, v28
    v_mul_f32 v97, v97, v28
    v_mul_f32 v98, v98, v28
    v_mfma_f32_16x16x32_bf16 v[124:127], v[196:199], v[164:167], v[124:127]
    ds_read_b64_tr_b16 v[220:221], v19 offset:8192
    ds_read_b64_tr_b16 v[222:223], v19 offset:12288
    v_mul_f32 v99, v99, v28
    v_mul_f32 v100, v100, v28
    v_mul_f32_e64 v101, v101, v28
    v_mfma_f32_16x16x32_bf16 v[112:115], v[200:203], v[168:171], v[112:115]
    v_mul_f32 v102, v102, v28
    v_mul_f32 v103, v103, v28
    v_cvt_pk_bf16_f32 v96, v96, v97
    v_mfma_f32_16x16x32_bf16 v[120:123], v[200:203], v[172:175], v[120:123]
    v_cvt_pk_bf16_f32 v97, v98, v99
    v_cvt_pk_bf16_f32 v98, v100, v101
    v_cvt_pk_bf16_f32 v99, v102, v103
    v_mfma_f32_16x16x32_bf16 v[116:119], v[204:207], v[168:171], v[116:119]
    buffer_store_dwordx4 v[96:99], v1, s[12:15], s55 offen offset:0
    v_mul_f32 v104, v104, v29
    v_mul_f32 v105, v105, v29
    v_mfma_f32_16x16x32_bf16 v[124:127], v[204:207], v[172:175], v[124:127]
    v_mul_f32 v106, v106, v29
    v_mul_f32 v107, v107, v29
    v_mul_f32 v108, v108, v29
    s_waitcnt lgkmcnt(0)
    s_barrier
    s_waitcnt lgkmcnt(0)
    v_mfma_f32_16x16x32_bf16 v[112:115], v[208:211], v[176:179], v[112:115]
    v_mul_f32 v109, v109, v29
    v_mul_f32 v110, v110, v29
    v_mul_f32_e64 v111, v111, v29
    v_mfma_f32_16x16x32_bf16 v[120:123], v[208:211], v[180:183], v[120:123]
    v_cvt_pk_bf16_f32 v104, v104, v105
    v_cvt_pk_bf16_f32 v105, v106, v107
    v_cvt_pk_bf16_f32 v106, v108, v109
    v_mfma_f32_16x16x32_bf16 v[116:119], v[212:215], v[176:179], v[116:119]
    v_cvt_pk_bf16_f32 v107, v110, v111
    buffer_store_dwordx4 v[104:107], v1, s[12:15], s55 offen offset:1024
    v_mfma_f32_16x16x32_bf16 v[124:127], v[212:215], v[180:183], v[124:127]
    v_mfma_f32_16x16x32_bf16 v[112:115], v[216:219], v[184:187], v[112:115]
    v_mfma_f32_16x16x32_bf16 v[120:123], v[216:219], v[188:191], v[120:123]
    v_mfma_f32_16x16x32_bf16 v[116:119], v[220:223], v[184:187], v[116:119]
    v_mfma_f32_16x16x32_bf16 v[124:127], v[220:223], v[188:191], v[124:127]
    s_nop 4
    v_mul_f32 v112, v112, v28
    v_mul_f32 v113, v113, v28
    v_mul_f32 v114, v114, v28
    v_mul_f32 v115, v115, v28
    v_mul_f32 v116, v116, v28
    v_mul_f32 v117, v117, v28
    v_mul_f32 v118, v118, v28
    v_mul_f32_e64 v119, v119, v28
    v_cvt_pk_bf16_f32 v112, v112, v113
    v_cvt_pk_bf16_f32 v113, v114, v115
    v_cvt_pk_bf16_f32 v114, v116, v117
    v_cvt_pk_bf16_f32 v115, v118, v119
    buffer_store_dwordx4 v[112:115], v1, s[12:15], s55 offen offset:2048
    v_mul_f32 v120, v120, v29
    v_mul_f32 v121, v121, v29
    v_mul_f32 v122, v122, v29
    v_mul_f32 v123, v123, v29
    v_mul_f32 v124, v124, v29
    v_mul_f32 v125, v125, v29
    v_mul_f32 v126, v126, v29
    v_mul_f32 v127, v127, v29
    v_cvt_pk_bf16_f32 v120, v120, v121
    v_cvt_pk_bf16_f32 v121, v122, v123
    v_cvt_pk_bf16_f32 v122, v124, v125
    v_cvt_pk_bf16_f32 v123, v126, v127
    buffer_store_dwordx4 v[120:123], v1, s[12:15], s55 offen offset:3072
L_fb_ret:
    v_mov_b32_e64 v31, 1
    s_mov_b64 exec, 1
    s_cmp_eq_u32 s57, 1
    s_waitcnt vmcnt(0)
    s_cbranch_scc1 L_opub_f
    buffer_wbl2 sc1
    s_waitcnt vmcnt(0)
    buffer_store_dword v31, off, s[12:15], s89 sc1
    s_branch L_opub_d
L_opub_f:
    buffer_store_dword v31, off, s[12:15], s89
L_opub_d:
    s_mov_b64 exec, -1
    v_mov_b32 v64, 0
L_pg4:
    s_cbranch_execz L_wret
    v_mov_b32 v65, 0
    v_mov_b32 v66, 0
    v_mov_b32 v67, 0
    v_mov_b32 v68, 0
    v_mov_b32 v69, 0
    v_mov_b32 v70, 0
    v_mov_b32 v71, 0
    v_mov_b32 v72, 0
    v_mov_b32 v73, 0
    v_mov_b32 v74, 0
    v_mov_b32 v75, 0
    v_mov_b32 v76, 0
    v_mov_b32 v77, 0
    v_mov_b32 v78, 0
    v_mov_b32 v79, 0
    v_mov_b32 v80, 0
    v_mov_b32 v81, 0
    v_mov_b32 v82, 0
    v_mov_b32 v83, 0
    v_mov_b32 v84, 0
    v_mov_b32 v85, 0
    v_mov_b32 v86, 0
    v_mov_b32 v87, 0
    v_mov_b32 v88, 0
    v_mov_b32 v89, 0
    v_mov_b32 v90, 0
    v_mov_b32 v91, 0
    v_mov_b32 v92, 0
    v_mov_b32 v93, 0
    v_mov_b32 v94, 0
    v_mov_b32 v95, 0
    v_mov_b32 v96, 0
    v_mov_b32 v97, 0
    v_mov_b32 v98, 0
    v_mov_b32 v99, 0
    v_mov_b32 v100, 0
    v_mov_b32 v101, 0
    v_mov_b32 v102, 0
    v_mov_b32 v103, 0
    v_mov_b32 v104, 0
    v_mov_b32 v105, 0
    v_mov_b32 v106, 0
    v_mov_b32 v107, 0
    v_mov_b32 v108, 0
    v_mov_b32 v109, 0
    v_mov_b32 v110, 0
    v_mov_b32 v111, 0
    v_mov_b32 v112, 0
    v_mov_b32 v113, 0
    v_mov_b32 v114, 0
    v_mov_b32 v115, 0
    v_mov_b32 v116, 0
    v_mov_b32 v117, 0
    v_mov_b32 v118, 0
    v_mov_b32 v119, 0
    v_mov_b32 v120, 0
    v_mov_b32 v121, 0
    v_mov_b32 v122, 0
    v_mov_b32 v123, 0
    v_mov_b32 v124, 0
    v_mov_b32 v125, 0
    v_mov_b32 v126, 0
    v_mov_b32 v127, 0
    s_mov_b32 s16, s70
    s_mov_b32 s17, s71
    s_mov_b32 s18, 2097152
    s_mov_b32 s19, 0x20000
    s_mov_b32 s4, 0x96251098
    s_mov_b32 s5, 0x10962510
    s_mov_b32 s6, 0x34783473
    s_mov_b32 s7, 0x54783478
    s_and_b32 s8, s4, 15
    s_lshl_b32 s8, s8, 14
    s_lshr_b64 s[4:5], s[4:5], 4
    s_and_b32 s9, s6, 15
    s_lshl_b32 s9, s9, 14
    s_lshr_b64 s[6:7], s[6:7], 4
    v_add_u32 v234, s8, v20
    v_add_u32 v235, s8, v21
    v_add_u32 v236, s8, v22
    v_add_u32 v237, s8, v23
    v_add_u32 v238, s9, v232
    v_add_u32 v239, s9, v233
    v_add_u32 v2, 0, v20
    v_add_u32 v3, 0, v21
    v_add_u32 v4, 0, v22
    v_add_u32 v5, 0, v23
    v_add_u32 v6, 65536, v232
    v_add_u32 v7, 65536, v233
    v_add_u32 v8, 16384, v20
    v_add_u32 v9, 16384, v21
    v_add_u32 v10, 16384, v22
    v_add_u32 v11, 16384, v23
    v_add_u32 v12, 81920, v232
    v_add_u32 v13, 81920, v233
    s_mov_b32 s49, -2
    buffer_load_dword v26, v27, s[12:15], s87 offen sc1
    s_barrier
    ds_read_b64_tr_b16 v[128:129], v234 offset:0
    ds_read_b64_tr_b16 v[130:131], v234 offset:4096
    ds_read_b128 v[144:147], v238 offset:0
    ds_read_b128 v[148:151], v238 offset:1024
    ds_read_b128 v[152:155], v239 offset:0
    ds_read_b128 v[156:159], v239 offset:1024
    ds_read_b64_tr_b16 v[132:133], v235 offset:0
    ds_read_b64_tr_b16 v[134:135], v235 offset:4096
    ds_read_b64_tr_b16 v[136:137], v236 offset:0
    ds_read_b64_tr_b16 v[138:139], v236 offset:4096
    ds_read_b64_tr_b16 v[140:141], v237 offset:0
    ds_read_b64_tr_b16 v[142:143], v237 offset:4096
    s_branch L3_cin
    s_nop 0
    s_nop 0
    s_nop 0
    s_nop 0
    s_nop 0
    s_nop 0
    s_nop 0
L_pg5:
    s_cbranch_execz L_wret
L3_cloop:
    s_waitcnt lgkmcnt(8)
    v_mfma_f32_16x16x32_bf16 v[64:67], v[128:131], v[144:147], v[64:67]
    ds_read_b64_tr_b16 v[160:161], v234 offset:8192
    v_mfma_f32_16x16x32_bf16 v[68:71], v[128:131], v[148:151], v[68:71]
    ds_read_b64_tr_b16 v[162:163], v234 offset:12288
    s_waitcnt lgkmcnt(8)
    v_mfma_f32_16x16x32_bf16 v[80:83], v[128:131], v[152:155], v[80:83]
    ds_read_b128 v[176:179], v238 offset:2048
    v_mfma_f32_16x16x32_bf16 v[84:87], v[128:131], v[156:159], v[84:87]
    ds_read_b128 v[180:183], v238 offset:3072
    s_waitcnt lgkmcnt(8)
    v_mfma_f32_16x16x32_bf16 v[72:75], v[132:135], v[144:147], v[72:75]
    ds_read_b128 v[184:187], v239 offset:2048
    v_mfma_f32_16x16x32_bf16 v[76:79], v[132:135], v[148:151], v[76:79]
    ds_read_b128 v[188:191], v239 offset:3072
    v_mfma_f32_16x16x32_bf16 v[88:91], v[132:135], v[152:155], v[88:91]
    ds_read_b64_tr_b16 v[164:165], v235 offset:8192
    v_mfma_f32_16x16x32_bf16 v[92:95], v[132:135], v[156:159], v[92:95]
    ds_read_b64_tr_b16 v[166:167], v235 offset:12288
    s_waitcnt lgkmcnt(10)
    v_mfma_f32_16x16x32_bf16 v[96:99], v[136:139], v[144:147], v[96:99]
    ds_read_b64_tr_b16 v[168:169], v236 offset:8192
    v_mfma_f32_16x16x32_bf16 v[100:103], v[136:139], v[148:151], v[100:103]
    ds_read_b64_tr_b16 v[170:171], v236 offset:12288
    v_mfma_f32_16x16x32_bf16 v[112:115], v[136:139], v[152:155], v[112:115]
    ds_read_b64_tr_b16 v[172:173], v237 offset:8192
    v_mfma_f32_16x16x32_bf16 v[116:119], v[136:139], v[156:159], v[116:119]
    ds_read_b64_tr_b16 v[174:175], v237 offset:12288
    s_waitcnt lgkmcnt(12)
    v_mfma_f32_16x16x32_bf16 v[104:107], v[140:143], v[144:147], v[104:107]
    s_and_b32 s8, s4, 15
    s_lshl_b32 s8, s8, 14
    v_mfma_f32_16x16x32_bf16 v[108:111], v[140:143], v[148:151], v[108:111]
    s_lshr_b64 s[4:5], s[4:5], 4
    s_and_b32 s9, s6, 15
    v_mfma_f32_16x16x32_bf16 v[120:123], v[140:143], v[152:155], v[120:123]
    s_lshl_b32 s9, s9, 14
    s_lshr_b64 s[6:7], s[6:7], 4
    v_mfma_f32_16x16x32_bf16 v[124:127], v[140:143], v[156:159], v[124:127]
    s_waitcnt lgkmcnt(8)
    v_mfma_f32_16x16x32_bf16 v[64:67], v[160:163], v[176:179], v[64:67]
    v_add_u32 v234, s8, v20
    v_add_u32_e64 v235, s8, v21
    v_mfma_f32_16x16x32_bf16 v[68:71], v[160:163], v[180:183], v[68:71]
    v_add_u32_e64 v236, s8, v22
    v_add_u32 v237, s8, v23
    s_waitcnt lgkmcnt(6)
    v_mfma_f32_16x16x32_bf16 v[80:83], v[160:163], v[184:187], v[80:83]
    v_add_u32 v238, s9, v232
    v_add_u32 v239, s9, v233
    v_mfma_f32_16x16x32_bf16 v[84:87], v[160:163], v[188:191], v[84:87]
    s_waitcnt lgkmcnt(0)
    s_barrier
    ds_read_b64_tr_b16 v[128:129], v234 offset:0
    v_mfma_f32_16x16x32_bf16 v[72:75], v[164:167], v[176:179], v[72:75]
    ds_read_b64_tr_b16 v[130:131], v234 offset:4096
    v_mfma_f32_16x16x32_bf16 v[76:79], v[164:167], v[180:183], v[76:79]
    ds_read_b128 v[144:147], v238 offset:0
    v_mfma_f32_16x16x32_bf16 v[88:91], v[164:167], v[184:187], v[88:91]
    ds_read_b128 v[148:151], v238 offset:1024
    v_mfma_f32_16x16x32_bf16 v[92:95], v[164:167], v[188:191], v[92:95]
    ds_read_b128 v[152:155], v239 offset:0
    v_mfma_f32_16x16x32_bf16 v[96:99], v[168:171], v[176:179], v[96:99]
    ds_read_b128 v[156:159], v239 offset:1024
    v_mfma_f32_16x16x32_bf16 v[100:103], v[168:171], v[180:183], v[100:103]
    ds_read_b64_tr_b16 v[132:133], v235 offset:0
    v_mfma_f32_16x16x32_bf16 v[112:115], v[168:171], v[184:187], v[112:115]
    ds_read_b64_tr_b16 v[134:135], v235 offset:4096
    v_mfma_f32_16x16x32_bf16 v[116:119], v[168:171], v[188:191], v[116:119]
    ds_read_b64_tr_b16 v[136:137], v236 offset:0
    v_mfma_f32_16x16x32_bf16 v[104:107], v[172:175], v[176:179], v[104:107]
    ds_read_b64_tr_b16 v[138:139], v236 offset:4096
    v_mfma_f32_16x16x32_bf16 v[108:111], v[172:175], v[180:183], v[108:111]
    ds_read_b64_tr_b16 v[140:141], v237 offset:0
    v_mfma_f32_16x16x32_bf16 v[120:123], v[172:175], v[184:187], v[120:123]
    ds_read_b64_tr_b16 v[142:143], v237 offset:4096
    v_mfma_f32_16x16x32_bf16 v[124:127], v[172:175], v[188:191], v[124:127]
L3_cin:
L_pg6:
    s_cbranch_execz L_wret
    s_waitcnt lgkmcnt(8)
    v_mfma_f32_16x16x32_bf16 v[64:67], v[128:131], v[144:147], v[64:67]
    ds_read_b64_tr_b16 v[160:161], v234 offset:8192
    v_mfma_f32_16x16x32_bf16 v[68:71], v[128:131], v[148:151], v[68:71]
    ds_read_b64_tr_b16 v[162:163], v234 offset:12288
    s_waitcnt lgkmcnt(8)
    v_mfma_f32_16x16x32_bf16 v[80:83], v[128:131], v[152:155], v[80:83]
    ds_read_b128 v[176:179], v238 offset:2048
    v_mfma_f32_16x16x32_bf16 v[84:87], v[128:131], v[156:159], v[84:87]
    ds_read_b128 v[180:183], v238 offset:3072
    s_waitcnt lgkmcnt(8)
    v_mfma_f32_16x16x32_bf16 v[72:75], v[132:135], v[144:147], v[72:75]
    ds_read_b128 v[184:187], v239 offset:2048
    v_mfma_f32_16x16x32_bf16 v[76:79], v[132:135], v[148:151], v[76:79]
    ds_read_b128 v[188:191], v239 offset:3072
    v_mfma_f32_16x16x32_bf16 v[88:91], v[132:135], v[152:155], v[88:91]
    ds_read_b64_tr_b16 v[164:165], v235 offset:8192
    v_mfma_f32_16x16x32_bf16 v[92:95], v[132:135], v[156:159], v[92:95]
    ds_read_b64_tr_b16 v[166:167], v235 offset:12288
    s_waitcnt lgkmcnt(10)
    v_mfma_f32_16x16x32_bf16 v[96:99], v[136:139], v[144:147], v[96:99]
    ds_read_b64_tr_b16 v[168:169], v236 offset:8192
    v_mfma_f32_16x16x32_bf16 v[100:103], v[136:139], v[148:151], v[100:103]
    ds_read_b64_tr_b16 v[170:171], v236 offset:12288
    v_mfma_f32_16x16x32_bf16 v[112:115], v[136:139], v[152:155], v[112:115]
    ds_read_b64_tr_b16 v[172:173], v237 offset:8192
    v_mfma_f32_16x16x32_bf16 v[116:119], v[136:139], v[156:159], v[116:119]
    ds_read_b64_tr_b16 v[174:175], v237 offset:12288
    s_waitcnt lgkmcnt(12)
    v_mfma_f32_16x16x32_bf16 v[104:107], v[140:143], v[144:147], v[104:107]
    s_and_b32 s8, s4, 15
    s_lshl_b32 s8, s8, 14
    v_mfma_f32_16x16x32_bf16 v[108:111], v[140:143], v[148:151], v[108:111]
    s_lshr_b64 s[4:5], s[4:5], 4
    s_and_b32 s9, s6, 15
    v_mfma_f32_16x16x32_bf16 v[120:123], v[140:143], v[152:155], v[120:123]
    s_lshl_b32 s9, s9, 14
    s_lshr_b64 s[6:7], s[6:7], 4
    v_mfma_f32_16x16x32_bf16 v[124:127], v[140:143], v[156:159], v[124:127]
    s_add_u32 s49, s49, 2
    s_cmp_eq_u32 s49, 12
    s_cbranch_scc1 L3_clast
    s_waitcnt lgkmcnt(8)
    v_mfma_f32_16x16x32_bf16 v[64:67], v[160:163], v[176:179], v[64:67]
    v_add_u32 v234, s8, v20
    v_add_u32 v235, s8, v21
    v_mfma_f32_16x16x32_bf16 v[68:71], v[160:163], v[180:183], v[68:71]
    v_add_u32_e64 v236, s8, v22
    v_add_u32 v237, s8, v23
    s_waitcnt lgkmcnt(6)
    v_mfma_f32_16x16x32_bf16 v[80:83], v[160:163], v[184:187], v[80:83]
    v_add_u32 v238, s9, v232
    v_add_u32 v239, s9, v233
    v_mfma_f32_16x16x32_bf16 v[84:87], v[160:163], v[188:191], v[84:87]
    s_waitcnt lgkmcnt(0)
    s_barrier
    ds_read_b64_tr_b16 v[128:129], v234 offset:0
    v_mfma_f32_16x16x32_bf16 v[72:75], v[164:167], v[176:179], v[72:75]
    ds_read_b64_tr_b16 v[130:131], v234 offset:4096
    v_mfma_f32_16x16x32_bf16 v[76:79], v[164:167], v[180:183], v[76:79]
    ds_read_b128 v[144:147], v238 offset:0
    v_mfma_f32_16x16x32_bf16 v[88:91], v[164:167], v[184:187], v[88:91]
    ds_read_b128 v[148:151], v238 offset:1024
    v_mfma_f32_16x16x32_bf16 v[92:95], v[164:167], v[188:191], v[92:95]
    ds_read_b128 v[152:155], v239 offset:0
    v_mfma_f32_16x16x32_bf16 v[96:99], v[168:171], v[176:179], v[96:99]
    ds_read_b128 v[156:159], v239 offset:1024
    v_mfma_f32_16x16x32_bf16 v[100:103], v[168:171], v[180:183], v[100:103]
    ds_read_b64_tr_b16 v[132:133], v235 offset:0
    v_mfma_f32_16x16x32_bf16 v[112:115], v[168:171], v[184:187], v[112:115]
    ds_read_b64_tr_b16 v[134:135], v235 offset:4096
    v_mfma_f32_16x16x32_bf16 v[116:119], v[168:171], v[188:191], v[116:119]
    ds_read_b64_tr_b16 v[136:137], v236 offset:0
    v_mfma_f32_16x16x32_bf16 v[104:107], v[172:175], v[176:179], v[104:107]
    ds_read_b64_tr_b16 v[138:139], v236 offset:4096
    v_mfma_f32_16x16x32_bf16 v[108:111], v[172:175], v[180:183], v[108:111]
    ds_read_b64_tr_b16 v[140:141], v237 offset:0
    v_mfma_f32_16x16x32_bf16 v[120:123], v[172:175], v[184:187], v[120:123]
    ds_read_b64_tr_b16 v[142:143], v237 offset:4096
    v_mfma_f32_16x16x32_bf16 v[124:127], v[172:175], v[188:191], v[124:127]
    s_branch L3_cloop
L_pg7:
    s_cbranch_execz L_wret
L3_clast:
    s_waitcnt lgkmcnt(9)
    v_mfma_f32_16x16x32_bf16 v[64:67], v[160:163], v[176:179], v[64:67]
    v_add_u32 v234, s8, v20
    v_add_u32 v235, s8, v21
    s_waitcnt lgkmcnt(8)
    v_mfma_f32_16x16x32_bf16 v[68:71], v[160:163], v[180:183], v[68:71]
    v_add_u32_e64 v236, s8, v22
    v_add_u32 v237, s8, v23
    s_waitcnt lgkmcnt(7)
    v_mfma_f32_16x16x32_bf16 v[80:83], v[160:163], v[184:187], v[80:83]
    v_add_u32_e64 v238, s9, v232
    v_add_u32 v239, s9, v233
    s_waitcnt lgkmcnt(6)
    v_mfma_f32_16x16x32_bf16 v[84:87], v[160:163], v[188:191], v[84:87]
    s_waitcnt lgkmcnt(0)
    s_barrier
    ds_read_b64_tr_b16 v[128:129], v234 offset:0
    ds_read_b64_tr_b16 v[130:131], v234 offset:4096
    ds_read_b128 v[132:135], v238 offset:0
    v_mfma_f32_16x16x32_bf16 v[72:75], v[164:167], v[176:179], v[72:75]
    ds_read_b128 v[136:139], v238 offset:1024
    v_mfma_f32_16x16x32_bf16 v[76:79], v[164:167], v[180:183], v[76:79]
    ds_read_b64_tr_b16 v[140:141], v235 offset:0
    ds_read_b64_tr_b16 v[142:143], v235 offset:4096
    v_mfma_f32_16x16x32_bf16 v[88:91], v[164:167], v[184:187], v[88:91]
    ds_read_b64_tr_b16 v[144:145], v234 offset:8192
    v_mfma_f32_16x16x32_bf16 v[92:95], v[164:167], v[188:191], v[92:95]
    ds_read_b64_tr_b16 v[146:147], v234 offset:12288
    ds_read_b128 v[148:151], v238 offset:2048
    v_mfma_f32_16x16x32_bf16 v[96:99], v[168:171], v[176:179], v[96:99]
    ds_read_b128 v[152:155], v238 offset:3072
    v_mfma_f32_16x16x32_bf16 v[100:103], v[168:171], v[180:183], v[100:103]
    ds_read_b64_tr_b16 v[156:157], v235 offset:8192
    ds_read_b64_tr_b16 v[158:159], v235 offset:12288
    v_mfma_f32_16x16x32_bf16 v[112:115], v[168:171], v[184:187], v[112:115]
    ds_read_b128 v[192:195], v239 offset:0
    v_mfma_f32_16x16x32_bf16 v[116:119], v[168:171], v[188:191], v[116:119]
    ds_read_b128 v[196:199], v239 offset:1024
    ds_read_b128 v[200:203], v239 offset:2048
    v_mfma_f32_16x16x32_bf16 v[104:107], v[172:175], v[176:179], v[104:107]
    ds_read_b128 v[204:207], v239 offset:3072
    v_mfma_f32_16x16x32_bf16 v[108:111], v[172:175], v[180:183], v[108:111]
    v_mfma_f32_16x16x32_bf16 v[120:123], v[172:175], v[184:187], v[120:123]
    s_barrier
    ds_read_b64_tr_b16 v[208:209], v2 offset:0
    ds_read_b64_tr_b16 v[210:211], v2 offset:4096
    ds_read_b128 v[212:215], v6 offset:0
    v_mfma_f32_16x16x32_bf16 v[124:127], v[172:175], v[188:191], v[124:127]
    ds_read_b128 v[216:219], v6 offset:1024
    s_waitcnt lgkmcnt(14)
    v_mfma_f32_16x16x32_bf16 v[64:67], v[128:131], v[132:135], v[64:67]
    ds_read_b64_tr_b16 v[220:221], v3 offset:0
    ds_read_b64_tr_b16 v[222:223], v3 offset:4096
    v_mfma_f32_16x16x32_bf16 v[68:71], v[128:131], v[136:139], v[68:71]
    ds_read_b64_tr_b16 v[224:225], v2 offset:8192
    v_mfma_f32_16x16x32_bf16 v[72:75], v[140:143], v[132:135], v[72:75]
    ds_read_b64_tr_b16 v[226:227], v2 offset:12288
    ds_read_b128 v[228:231], v6 offset:2048
    v_mfma_f32_16x16x32_bf16 v[76:79], v[140:143], v[136:139], v[76:79]
    ds_read_b128 v[32:35], v6 offset:3072
    s_waitcnt lgkmcnt(14)
    v_mfma_f32_16x16x32_bf16 v[64:67], v[144:147], v[148:151], v[64:67]
    ds_read_b64_tr_b16 v[36:37], v3 offset:8192
    ds_read_b64_tr_b16 v[38:39], v3 offset:12288
    v_mfma_f32_16x16x32_bf16 v[68:71], v[144:147], v[152:155], v[68:71]
    ds_read_b128 v[40:43], v7 offset:0
    v_mfma_f32_16x16x32_bf16 v[72:75], v[156:159], v[148:151], v[72:75]
    s_barrier
    ds_read_b64_tr_b16 v[44:45], v8 offset:0
    ds_read_b64_tr_b16 v[46:47], v8 offset:4096
    v_mfma_f32_16x16x32_bf16 v[76:79], v[156:159], v[152:155], v[76:79]
    ds_read_b128 v[48:51], v12 offset:0
    s_waitcnt lgkmcnt(10)
    v_mfma_f32_16x16x32_bf16 v[64:67], v[208:211], v[212:215], v[64:67]
    ds_read_b128 v[52:55], v12 offset:1024
    ds_read_b64_tr_b16 v[56:57], v9 offset:0
    v_mfma_f32_16x16x32_bf16 v[68:71], v[208:211], v[216:219], v[68:71]
    ds_read_b64_tr_b16 v[58:59], v9 offset:4096
    v_mfma_f32_16x16x32_bf16 v[72:75], v[220:223], v[212:215], v[72:75]
    ds_read_b64_tr_b16 v[60:61], v8 offset:8192
    ds_read_b64_tr_b16 v[62:63], v8 offset:12288
    v_mfma_f32_16x16x32_bf16 v[76:79], v[220:223], v[216:219], v[76:79]
    ds_read_b128 v[240:243], v12 offset:2048
    s_waitcnt lgkmcnt(10)
    v_mfma_f32_16x16x32_bf16 v[64:67], v[224:227], v[228:231], v[64:67]
    ds_read_b128 v[244:247], v12 offset:3072
    ds_read_b64_tr_b16 v[160:161], v9 offset:8192
    v_mfma_f32_16x16x32_bf16 v[68:71], v[224:227], v[32:35], v[68:71]
    ds_read_b64_tr_b16 v[162:163], v9 offset:12288
    v_mfma_f32_16x16x32_bf16 v[72:75], v[36:39], v[228:231], v[72:75]
    ds_read_b128 v[164:167], v7 offset:1024
    ds_read_b128 v[168:171], v7 offset:2048
    v_mfma_f32_16x16x32_bf16 v[76:79], v[36:39], v[32:35], v[76:79]
    ds_read_b128 v[176:179], v7 offset:3072
    s_waitcnt lgkmcnt(9)
    v_mfma_f32_16x16x32_bf16 v[64:67], v[44:47], v[48:51], v[64:67]
    ds_read_b128 v[180:183], v13 offset:0
    ds_read_b128 v[184:187], v13 offset:1024
    v_mfma_f32_16x16x32_bf16 v[68:71], v[44:47], v[52:55], v[68:71]
    ds_read_b128 v[172:175], v13 offset:2048
    v_mfma_f32_16x16x32_bf16 v[72:75], v[56:59], v[48:51], v[72:75]
    ds_read_b128 v[188:191], v13 offset:3072
    v_mfma_f32_16x16x32_bf16 v[76:79], v[56:59], v[52:55], v[76:79]
    s_waitcnt lgkmcnt(7)
    v_mfma_f32_16x16x32_bf16 v[64:67], v[60:63], v[240:243], v[64:67]
    s_waitcnt vmcnt(0)
    v_cmp_ne_u32 vcc, 1, v26
    v_mfma_f32_16x16x32_bf16 v[68:71], v[60:63], v[244:247], v[68:71]
    s_cbranch_vccnz L_xrdy_slow
L_xrdy_ret:
    v_mfma_f32_16x16x32_bf16 v[72:75], v[160:163], v[240:243], v[72:75]
    v_mfma_f32_16x16x32_bf16 v[76:79], v[160:163], v[244:247], v[76:79]
    v_mfma_f32_16x16x32_bf16 v[80:83], v[128:131], v[192:195], v[80:83]
    v_mfma_f32_16x16x32_bf16 v[84:87], v[128:131], v[196:199], v[84:87]
    v_cvt_pk_bf16_f32 v64, v64, v65
    v_cvt_pk_bf16_f32 v65, v66, v67
    s_nop 0
    v_cvt_pk_bf16_f32 v66, v68, v69
    v_mfma_f32_16x16x32_bf16 v[88:91], v[140:143], v[192:195], v[88:91]
    ds_read_b64_tr_b16 v[128:129], v236 offset:0
    ds_read_b64_tr_b16 v[130:131], v236 offset:4096
    v_cvt_pk_bf16_f32 v67, v70, v71
    buffer_store_dwordx4 v[64:67], v1, s[12:15], s80 offen offset:0 sc1
    v_mfma_f32_16x16x32_bf16 v[92:95], v[140:143], v[196:199], v[92:95]
    v_cvt_pk_bf16_f32 v72, v72, v73
    v_cvt_pk_bf16_f32 v73, v74, v75
    v_cvt_pk_bf16_f32 v74, v76, v77
    v_mfma_f32_16x16x32_bf16 v[80:83], v[144:147], v[200:203], v[80:83]
    ds_read_b64_tr_b16 v[140:141], v237 offset:0
    ds_read_b64_tr_b16 v[142:143], v237 offset:4096
    v_cvt_pk_bf16_f32 v75, v78, v79
    buffer_store_dwordx4 v[72:75], v1, s[12:15], s80 offen offset:1024 sc1
    v_mfma_f32_16x16x32_bf16 v[84:87], v[144:147], v[204:207], v[84:87]
    v_mfma_f32_16x16x32_bf16 v[88:91], v[156:159], v[200:203], v[88:91]
    ds_read_b64_tr_b16 v[144:145], v236 offset:8192
    ds_read_b64_tr_b16 v[146:147], v236 offset:12288
    v_mfma_f32_16x16x32_bf16 v[92:95], v[156:159], v[204:207], v[92:95]
    v_mfma_f32_16x16x32_bf16 v[80:83], v[208:211], v[40:43], v[80:83]
    ds_read_b64_tr_b16 v[156:157], v237 offset:8192
    ds_read_b64_tr_b16 v[158:159], v237 offset:12288
    s_waitcnt lgkmcnt(14)
    v_mfma_f32_16x16x32_bf16 v[84:87], v[208:211], v[164:167], v[84:87]
    v_mfma_f32_16x16x32_bf16 v[88:91], v[220:223], v[40:43], v[88:91]
    ds_read_b64_tr_b16 v[208:209], v4 offset:0
    ds_read_b64_tr_b16 v[210:211], v4 offset:4096
    v_mfma_f32_16x16x32_bf16 v[92:95], v[220:223], v[164:167], v[92:95]
    s_waitcnt lgkmcnt(14)
    v_mfma_f32_16x16x32_bf16 v[80:83], v[224:227], v[168:171], v[80:83]
    ds_read_b64_tr_b16 v[220:221], v5 offset:0
    ds_read_b64_tr_b16 v[222:223], v5 offset:4096
    v_mfma_f32_16x16x32_bf16 v[84:87], v[224:227], v[176:179], v[84:87]
    v_mfma_f32_16x16x32_bf16 v[88:91], v[36:39], v[168:171], v[88:91]
    ds_read_b64_tr_b16 v[224:225], v4 offset:8192
    ds_read_b64_tr_b16 v[226:227], v4 offset:12288
    v_mfma_f32_16x16x32_bf16 v[92:95], v[36:39], v[176:179], v[92:95]
    s_waitcnt lgkmcnt(15)
    v_mfma_f32_16x16x32_bf16 v[80:83], v[44:47], v[180:183], v[80:83]
    ds_read_b64_tr_b16 v[36:37], v5 offset:8192
    ds_read_b64_tr_b16 v[38:39], v5 offset:12288
    v_mfma_f32_16x16x32_bf16 v[84:87], v[44:47], v[184:187], v[84:87]
    v_mfma_f32_16x16x32_bf16 v[88:91], v[56:59], v[180:183], v[88:91]
    ds_read_b64_tr_b16 v[44:45], v10 offset:0
    ds_read_b64_tr_b16 v[46:47], v10 offset:4096
    v_mfma_f32_16x16x32_bf16 v[92:95], v[56:59], v[184:187], v[92:95]
    v_mfma_f32_16x16x32_bf16 v[80:83], v[60:63], v[172:175], v[80:83]
    ds_read_b64_tr_b16 v[56:57], v11 offset:0
    ds_read_b64_tr_b16 v[58:59], v11 offset:4096
    s_waitcnt lgkmcnt(15)
    v_mfma_f32_16x16x32_bf16 v[84:87], v[60:63], v[188:191], v[84:87]
    v_mfma_f32_16x16x32_bf16 v[88:91], v[160:163], v[172:175], v[88:91]
    ds_read_b64_tr_b16 v[60:61], v10 offset:8192
    ds_read_b64_tr_b16 v[62:63], v10 offset:12288
    v_mfma_f32_16x16x32_bf16 v[92:95], v[160:163], v[188:191], v[92:95]
    v_mfma_f32_16x16x32_bf16 v[96:99], v[128:131], v[132:135], v[96:99]
    ds_read_b64_tr_b16 v[160:161], v11 offset:8192
    ds_read_b64_tr_b16 v[162:163], v11 offset:12288
    v_mfma_f32_16x16x32_bf16 v[100:103], v[128:131], v[136:139], v[100:103]
    v_cvt_pk_bf16_f32 v80, v80, v81
    v_cvt_pk_bf16_f32 v81, v82, v83
    v_cvt_pk_bf16_f32 v82, v84, v85
    v_mfma_f32_16x16x32_bf16 v[104:107], v[140:143], v[132:135], v[104:107]
    v_cvt_pk_bf16_f32 v83, v86, v87
    buffer_store_dwordx4 v[80:83], v1, s[12:15], s81 offen offset:0 sc1
    v_mfma_f32_16x16x32_bf16 v[108:111], v[140:143], v[136:139], v[108:111]
    v_cvt_pk_bf16_f32 v88, v88, v89
    v_cvt_pk_bf16_f32 v89, v90, v91
    v_cvt_pk_bf16_f32 v90, v92, v93
    s_waitcnt lgkmcnt(15)
    v_mfma_f32_16x16x32_bf16 v[96:99], v[144:147], v[148:151], v[96:99]
    v_cvt_pk_bf16_f32 v91, v94, v95
    buffer_store_dwordx4 v[88:91], v1, s[12:15], s81 offen offset:1024 sc1
    v_mfma_f32_16x16x32_bf16 v[100:103], v[144:147], v[152:155], v[100:103]
    v_mfma_f32_16x16x32_bf16 v[104:107], v[156:159], v[148:151], v[104:107]
    v_mfma_f32_16x16x32_bf16 v[108:111], v[156:159], v[152:155], v[108:111]
    s_waitcnt lgkmcnt(12)
    v_mfma_f32_16x16x32_bf16 v[96:99], v[208:211], v[212:215], v[96:99]
    v_mfma_f32_16x16x32_bf16 v[100:103], v[208:211], v[216:219], v[100:103]
    v_mfma_f32_16x16x32_bf16 v[104:107], v[220:223], v[212:215], v[104:107]
    v_mfma_f32_16x16x32_bf16 v[108:111], v[220:223], v[216:219], v[108:111]
    s_waitcnt lgkmcnt(8)
    v_mfma_f32_16x16x32_bf16 v[96:99], v[224:227], v[228:231], v[96:99]
    v_mfma_f32_16x16x32_bf16 v[100:103], v[224:227], v[32:35], v[100:103]
    v_mfma_f32_16x16x32_bf16 v[104:107], v[36:39], v[228:231], v[104:107]
    v_mfma_f32_16x16x32_bf16 v[108:111], v[36:39], v[32:35], v[108:111]
    s_waitcnt lgkmcnt(4)
    v_mfma_f32_16x16x32_bf16 v[96:99], v[44:47], v[48:51], v[96:99]
    v_mfma_f32_16x16x32_bf16 v[100:103], v[44:47], v[52:55], v[100:103]
    v_mfma_f32_16x16x32_bf16 v[104:107], v[56:59], v[48:51], v[104:107]
    v_mfma_f32_16x16x32_bf16 v[108:111], v[56:59], v[52:55], v[108:111]
    s_waitcnt lgkmcnt(2)
    v_mfma_f32_16x16x32_bf16 v[96:99], v[60:63], v[240:243], v[96:99]
    v_mfma_f32_16x16x32_bf16 v[100:103], v[60:63], v[244:247], v[100:103]
    s_waitcnt lgkmcnt(0)
    v_mfma_f32_16x16x32_bf16 v[104:107], v[160:163], v[240:243], v[104:107]
    v_mfma_f32_16x16x32_bf16 v[108:111], v[160:163], v[244:247], v[108:111]
    v_mfma_f32_16x16x32_bf16 v[112:115], v[128:131], v[192:195], v[112:115]
    v_mfma_f32_16x16x32_bf16 v[116:119], v[128:131], v[196:199], v[116:119]
    s_nop 1
    v_cvt_pk_bf16_f32 v96, v96, v97
    v_cvt_pk_bf16_f32 v97, v98, v99
    v_cvt_pk_bf16_f32 v98, v100, v101
    v_mfma_f32_16x16x32_bf16 v[120:123], v[140:143], v[192:195], v[120:123]
    v_cvt_pk_bf16_f32 v99, v102, v103
    buffer_store_dwordx4 v[96:99], v1, s[12:15], s82 offen offset:0 sc1
    v_mfma_f32_16x16x32_bf16 v[124:127], v[140:143], v[196:199], v[124:127]
    v_cvt_pk_bf16_f32 v104, v104, v105
    v_cvt_pk_bf16_f32 v105, v106, v107
    v_cvt_pk_bf16_f32 v106, v108, v109
    v_mfma_f32_16x16x32_bf16 v[112:115], v[144:147], v[200:203], v[112:115]
    v_cvt_pk_bf16_f32 v107, v110, v111
    buffer_store_dwordx4 v[104:107], v1, s[12:15], s82 offen offset:1024 sc1
    v_mfma_f32_16x16x32_bf16 v[116:119], v[144:147], v[204:207], v[116:119]
    v_mfma_f32_16x16x32_bf16 v[120:123], v[156:159], v[200:203], v[120:123]
    v_mfma_f32_16x16x32_bf16 v[124:127], v[156:159], v[204:207], v[124:127]
    v_mfma_f32_16x16x32_bf16 v[112:115], v[208:211], v[40:43], v[112:115]
    v_mfma_f32_16x16x32_bf16 v[116:119], v[208:211], v[164:167], v[116:119]
    v_mfma_f32_16x16x32_bf16 v[120:123], v[220:223], v[40:43], v[120:123]
    v_mfma_f32_16x16x32_bf16 v[124:127], v[220:223], v[164:167], v[124:127]
    v_mfma_f32_16x16x32_bf16 v[112:115], v[224:227], v[168:171], v[112:115]
    v_mfma_f32_16x16x32_bf16 v[116:119], v[224:227], v[176:179], v[116:119]
    v_mfma_f32_16x16x32_bf16 v[120:123], v[36:39], v[168:171], v[120:123]
    v_mfma_f32_16x16x32_bf16 v[124:127], v[36:39], v[176:179], v[124:127]
    v_mfma_f32_16x16x32_bf16 v[112:115], v[44:47], v[180:183], v[112:115]
    v_mfma_f32_16x16x32_bf16 v[116:119], v[44:47], v[184:187], v[116:119]
    v_mfma_f32_16x16x32_bf16 v[120:123], v[56:59], v[180:183], v[120:123]
    v_mfma_f32_16x16x32_bf16 v[124:127], v[56:59], v[184:187], v[124:127]
    v_mfma_f32_16x16x32_bf16 v[112:115], v[60:63], v[172:175], v[112:115]
    v_mfma_f32_16x16x32_bf16 v[116:119], v[60:63], v[188:191], v[116:119]
    v_mfma_f32_16x16x32_bf16 v[120:123], v[160:163], v[172:175], v[120:123]
    v_mfma_f32_16x16x32_bf16 v[124:127], v[160:163], v[188:191], v[124:127]
    buffer_load_dwordx4 v[132:135], v1, s[12:15], s84 offen offset:0 sc1
    buffer_load_dwordx4 v[136:139], v1, s[12:15], s84 offen offset:1024 sc1
    buffer_load_dwordx4 v[148:151], v1, s[12:15], s84 offen offset:2048 sc1
    buffer_load_dwordx4 v[152:155], v1, s[12:15], s84 offen offset:3072 sc1
    buffer_load_dwordx4 v[212:215], v1, s[12:15], s85 offen offset:0 sc1
    buffer_load_dwordx4 v[216:219], v1, s[12:15], s85 offen offset:1024 sc1
    s_mov_b32 s56, 0
L_xchk:
    s_waitcnt vmcnt(5)
    v_max_u32 v30, v132, v133
    v_max3_u32 v30, v30, v134, v135
    s_waitcnt vmcnt(4)
    v_max3_u32 v30, v30, v136, v137
    v_max3_u32 v30, v30, v138, v139
    s_waitcnt vmcnt(3)
    v_max3_u32 v30, v30, v148, v149
    v_max3_u32 v30, v30, v150, v151
    s_waitcnt vmcnt(2)
    v_max3_u32 v30, v30, v152, v153
    v_max3_u32 v30, v30, v154, v155
    s_waitcnt vmcnt(1)
    v_max3_u32 v30, v30, v212, v213
    v_max3_u32 v30, v30, v214, v215
    s_waitcnt vmcnt(0)
    v_max3_u32 v30, v30, v216, v217
    v_max3_u32 v30, v30, v218, v219
    v_cmp_eq_u32 vcc, -1, v30
    s_nop 0
    s_cbranch_vccz L_xgot
    buffer_load_dwordx4 v[132:135], v1, s[12:15], s84 offen offset:0 sc1
    buffer_load_dwordx4 v[136:139], v1, s[12:15], s84 offen offset:1024 sc1
    buffer_load_dwordx4 v[148:151], v1, s[12:15], s84 offen offset:2048 sc1
    buffer_load_dwordx4 v[152:155], v1, s[12:15], s84 offen offset:3072 sc1
    buffer_load_dwordx4 v[212:215], v1, s[12:15], s85 offen offset:0 sc1
    buffer_load_dwordx4 v[216:219], v1, s[12:15], s85 offen offset:1024 sc1
    s_add_u32 s56, s56, 1
    s_cmp_lt_u32 s56, 262144
    s_cbranch_scc1 L_xchk
    s_waitcnt vmcnt(0)
L_xgot:
    s_mov_b32 s42, 0xffff0000
    v_lshlrev_b32 v2, 16, v132
    v_and_b32_e64 v3, s42, v132
    v_pk_add_f32 v[112:113], v[112:113], v[2:3]
    v_lshlrev_b32 v4, 16, v133
    v_and_b32 v5, s42, v133
    v_pk_add_f32 v[114:115], v[114:115], v[4:5]
    v_lshlrev_b32 v6, 16, v134
    v_and_b32 v7, s42, v134
    v_pk_add_f32 v[116:117], v[116:117], v[6:7]
    v_lshlrev_b32 v8, 16, v135
    v_and_b32 v9, s42, v135
    v_pk_add_f32 v[118:119], v[118:119], v[8:9]
    v_lshlrev_b32 v2, 16, v148
    v_and_b32 v3, s42, v148
    v_pk_add_f32 v[112:113], v[112:113], v[2:3]
    v_lshlrev_b32 v4, 16, v149
    v_and_b32 v5, s42, v149
    v_pk_add_f32 v[114:115], v[114:115], v[4:5]
    v_lshlrev_b32 v6, 16, v150
    v_and_b32 v7, s42, v150
    v_pk_add_f32 v[116:117], v[116:117], v[6:7]
    v_lshlrev_b32 v8, 16, v151
    v_and_b32 v9, s42, v151
    v_pk_add_f32 v[118:119], v[118:119], v[8:9]
    v_lshlrev_b32 v2, 16, v212
    v_and_b32 v3, s42, v212
    v_pk_add_f32 v[112:113], v[112:113], v[2:3]
    v_lshlrev_b32 v4, 16, v213
    v_and_b32 v5, s42, v213
    v_pk_add_f32 v[114:115], v[114:115], v[4:5]
    v_lshlrev_b32 v6, 16, v214
    v_and_b32 v7, s42, v214
    v_pk_add_f32 v[116:117], v[116:117], v[6:7]
    v_lshlrev_b32 v8, 16, v215
    v_and_b32 v9, s42, v215
    v_pk_add_f32 v[118:119], v[118:119], v[8:9]
    v_cvt_pk_bf16_f32 v112, v112, v113
    v_cvt_pk_bf16_f32 v113, v114, v115
    v_cvt_pk_bf16_f32 v114, v116, v117
    v_cvt_pk_bf16_f32 v115, v118, v119
    s_add_u32 s79, s78, 65536
    buffer_store_dwordx2 v[112:113], v24, s[16:19], s78 offen offset:0
    buffer_store_dwordx2 v[114:115], v24, s[16:19], s79 offen offset:0
    v_lshlrev_b32 v2, 16, v136
    v_and_b32 v3, s42, v136
    v_pk_add_f32 v[120:121], v[120:121], v[2:3]
    v_lshlrev_b32 v4, 16, v137
    v_and_b32 v5, s42, v137
    v_pk_add_f32 v[122:123], v[122:123], v[4:5]
    v_lshlrev_b32_e64 v6, 16, v138
    v_and_b32 v7, s42, v138
L_pg8:
    s_cbranch_execz L_wret
    v_pk_add_f32 v[124:125], v[124:125], v[6:7]
    v_lshlrev_b32 v8, 16, v139
    v_and_b32 v9, s42, v139
    v_pk_add_f32 v[126:127], v[126:127], v[8:9]
    v_lshlrev_b32 v2, 16, v152
    v_and_b32 v3, s42, v152
    v_pk_add_f32 v[120:121], v[120:121], v[2:3]
    v_lshlrev_b32 v4, 16, v153
    v_and_b32 v5, s42, v153
    v_pk_add_f32 v[122:123], v[122:123], v[4:5]
    v_lshlrev_b32 v6, 16, v154
    v_and_b32 v7, s42, v154
    v_pk_add_f32 v[124:125], v[124:125], v[6:7]
    v_lshlrev_b32 v8, 16, v155
    v_and_b32 v9, s42, v155
    v_pk_add_f32 v[126:127], v[126:127], v[8:9]
    v_lshlrev_b32 v2, 16, v216
    v_and_b32 v3, s42, v216
    v_pk_add_f32 v[120:121], v[120:121], v[2:3]
    v_lshlrev_b32 v4, 16, v217
    v_and_b32 v5, s42, v217
    v_pk_add_f32 v[122:123], v[122:123], v[4:5]
    v_lshlrev_b32 v6, 16, v218
    v_and_b32 v7, s42, v218
    v_pk_add_f32 v[124:125], v[124:125], v[6:7]
    v_lshlrev_b32 v8, 16, v219
    v_and_b32 v9, s42, v219
    v_pk_add_f32 v[126:127], v[126:127], v[8:9]
    v_cvt_pk_bf16_f32 v120, v120, v121
    v_cvt_pk_bf16_f32 v121, v122, v123
    v_cvt_pk_bf16_f32 v122, v124, v125
    v_cvt_pk_bf16_f32 v123, v126, v127
    buffer_store_dwordx2 v[120:121], v24, s[16:19], s78 offen offset:32
    buffer_store_dwordx2 v[122:123], v24, s[16:19], s79 offen offset:32
    s_endpgm
L_xrdy_slow:
    s_mov_b32 s56, 0
L_xrdy:
    buffer_load_dword v26, v27, s[12:15], s87 offen sc1
    s_add_u32 s56, s56, 1
    s_cmp_ge_u32 s56, 262144
    s_cbranch_scc1 L_xrdy_go
    s_waitcnt vmcnt(0)
L_xrdy_chk:
    v_cmp_eq_u32 vcc, 1, v26
    s_nop 0
    s_cmp_eq_u64 vcc, -1
    s_cbranch_scc0 L_xrdy
L_xrdy_go:
    s_branch L_xrdy_ret
L_fb:
    s_waitcnt lgkmcnt(0)
    s_barrier
    s_lshl_b32 s39, s58, 2
    s_add_u32 s39, s39, s33
    s_lshl_b32 s39, s39, 18
    s_add_u32 s20, s62, s39
    s_addc_u32 s21, s63, 0
    s_add_u32 s24, s64, s39
    s_addc_u32 s25, s65, 0
    s_mov_b32 s22, 262144
    s_mov_b32 s23, 0x20000
    s_mov_b32 s26, 262144
    s_mov_b32 s27, 0x20000
    v_and_b32 v10, 15, v0
    v_lshrrev_b32 v11, 4, v0
    v_lshlrev_b32 v12, 8, v10
    v_lshl_add_u32 v12, v11, 4, v12
    v_lshlrev_b32_e64 v13, 1, v10
    v_lshl_add_u32 v13, v11, 10, v13
    v_mov_b32 v64, 0
    v_mov_b32 v65, 0
    v_mov_b32 v66, 0
    v_mov_b32 v67, 0
    v_mov_b32 v68, 0
    v_mov_b32 v69, 0
    v_mov_b32 v70, 0
    v_mov_b32 v71, 0
    v_mov_b32 v72, 0
    v_mov_b32 v73, 0
    v_mov_b32 v74, 0
    v_mov_b32 v75, 0
    v_mov_b32 v76, 0
    v_mov_b32 v77, 0
    v_mov_b32 v78, 0
    v_mov_b32 v79, 0
    v_mov_b32 v80, 0
    v_mov_b32 v81, 0
    v_mov_b32 v82, 0
    v_mov_b32 v83, 0
    v_mov_b32 v84, 0
    v_mov_b32 v85, 0
    v_mov_b32 v86, 0
    v_mov_b32 v87, 0
    v_mov_b32 v88, 0
    v_mov_b32 v89, 0
    v_mov_b32 v90, 0
    v_mov_b32 v91, 0
    v_mov_b32 v92, 0
    v_mov_b32 v93, 0
    v_mov_b32 v94, 0
    v_mov_b32 v95, 0
    v_mov_b32 v96, 0
    v_mov_b32 v97, 0
    v_mov_b32 v98, 0
    v_mov_b32 v99, 0
    v_mov_b32 v100, 0
    v_mov_b32 v101, 0
    v_mov_b32 v102, 0
    v_mov_b32 v103, 0
    v_mov_b32 v104, 0
    v_mov_b32 v105, 0
    v_mov_b32 v106, 0
    v_mov_b32 v107, 0
    v_mov_b32 v108, 0
    v_mov_b32 v109, 0
    v_mov_b32 v110, 0
    v_mov_b32 v111, 0
    v_mov_b32 v112, 0
    v_mov_b32 v113, 0
    v_mov_b32 v114, 0
    v_mov_b32 v115, 0
    v_mov_b32 v116, 0
    v_mov_b32 v117, 0
    v_mov_b32 v118, 0
    v_mov_b32 v119, 0
    v_mov_b32 v120, 0
    v_mov_b32 v121, 0
    v_mov_b32 v122, 0
    v_mov_b32 v123, 0
    v_mov_b32 v124, 0
    v_mov_b32 v125, 0
    v_mov_b32 v126, 0
    v_mov_b32 v127, 0
    v_mov_b32 v14, 0xff7fffff
    v_mov_b32 v15, 0xff7fffff
    v_mov_b32_e64 v28, 0
    v_mov_b32 v29, 0
    s_mov_b32 s46, 0
L_fb_loop:
    s_add_u32 s47, s46, 4096
    buffer_load_dwordx4 v[192:195], v12, s[20:23], s46 offen offset:0
    buffer_load_dwordx4 v[196:199], v12, s[20:23], s46 offen offset:64
    buffer_load_dwordx4 v[200:203], v12, s[20:23], s46 offen offset:128
    buffer_load_dwordx4 v[204:207], v12, s[20:23], s46 offen offset:192
    buffer_load_dwordx4 v[208:211], v12, s[20:23], s47 offen offset:0
    buffer_load_dwordx4 v[212:215], v12, s[20:23], s47 offen offset:64
    buffer_load_dwordx4 v[216:219], v12, s[20:23], s47 offen offset:128
    buffer_load_dwordx4 v[220:223], v12, s[20:23], s47 offen offset:192
    s_waitcnt vmcnt(0)
    v_mfma_f32_16x16x32_bf16 v[128:131], v[192:195], v[32:35], 0
    v_mfma_f32_16x16x32_bf16 v[136:139], v[192:195], v[36:39], 0
    v_mfma_f32_16x16x32_bf16 v[128:131], v[196:199], v[40:43], v[128:131]
    v_mfma_f32_16x16x32_bf16 v[136:139], v[196:199], v[44:47], v[136:139]
    v_mfma_f32_16x16x32_bf16 v[128:131], v[200:203], v[48:51], v[128:131]
    v_mfma_f32_16x16x32_bf16 v[136:139], v[200:203], v[52:55], v[136:139]
    v_mfma_f32_16x16x32_bf16 v[128:131], v[204:207], v[56:59], v[128:131]
    v_mfma_f32_16x16x32_bf16 v[136:139], v[204:207], v[60:63], v[136:139]
    v_mfma_f32_16x16x32_bf16 v[132:135], v[208:211], v[32:35], 0
    v_mfma_f32_16x16x32_bf16 v[140:143], v[208:211], v[36:39], 0
    v_mfma_f32_16x16x32_bf16 v[132:135], v[212:215], v[40:43], v[132:135]
    v_mfma_f32_16x16x32_bf16 v[140:143], v[212:215], v[44:47], v[140:143]
    v_mfma_f32_16x16x32_bf16 v[132:135], v[216:219], v[48:51], v[132:135]
    v_mfma_f32_16x16x32_bf16 v[140:143], v[216:219], v[52:55], v[140:143]
    v_mfma_f32_16x16x32_bf16 v[132:135], v[220:223], v[56:59], v[132:135]
    v_mfma_f32_16x16x32_bf16 v[140:143], v[220:223], v[60:63], v[140:143]
    s_nop 7
    v_mov_b32_e64 v30, v143
    buffer_load_ushort v192, v13, s[24:27], s46 offen offset:0
    buffer_load_ushort v193, v13, s[24:27], s46 offen offset:256
    buffer_load_ushort v194, v13, s[24:27], s46 offen offset:512
    buffer_load_ushort v195, v13, s[24:27], s46 offen offset:768
    buffer_load_ushort v196, v13, s[24:27], s47 offen offset:0
    buffer_load_ushort v197, v13, s[24:27], s47 offen offset:256
    buffer_load_ushort v198, v13, s[24:27], s47 offen offset:512
    buffer_load_ushort v199, v13, s[24:27], s47 offen offset:768
    buffer_load_ushort v200, v13, s[24:27], s46 offen offset:32
    buffer_load_ushort v201, v13, s[24:27], s46 offen offset:288
    buffer_load_ushort v202, v13, s[24:27], s46 offen offset:544
    buffer_load_ushort v203, v13, s[24:27], s46 offen offset:800
    buffer_load_ushort v204, v13, s[24:27], s47 offen offset:32
    buffer_load_ushort v205, v13, s[24:27], s47 offen offset:288
    buffer_load_ushort v206, v13, s[24:27], s47 offen offset:544
    buffer_load_ushort v207, v13, s[24:27], s47 offen offset:800
    buffer_load_ushort v208, v13, s[24:27], s46 offen offset:64
    buffer_load_ushort v209, v13, s[24:27], s46 offen offset:320
    buffer_load_ushort v210, v13, s[24:27], s46 offen offset:576
    buffer_load_ushort v211, v13, s[24:27], s46 offen offset:832
    buffer_load_ushort v212, v13, s[24:27], s47 offen offset:64
    buffer_load_ushort v213, v13, s[24:27], s47 offen offset:320
    buffer_load_ushort v214, v13, s[24:27], s47 offen offset:576
    buffer_load_ushort v215, v13, s[24:27], s47 offen offset:832
    buffer_load_ushort v216, v13, s[24:27], s46 offen offset:96
    buffer_load_ushort v217, v13, s[24:27], s46 offen offset:352
    buffer_load_ushort v218, v13, s[24:27], s46 offen offset:608
    buffer_load_ushort v219, v13, s[24:27], s46 offen offset:864
    buffer_load_ushort v220, v13, s[24:27], s47 offen offset:96
    buffer_load_ushort v221, v13, s[24:27], s47 offen offset:352
    buffer_load_ushort v222, v13, s[24:27], s47 offen offset:608
    buffer_load_ushort v223, v13, s[24:27], s47 offen offset:864
    s_waitcnt vmcnt(0)
    v_lshl_or_b32 v144, v193, 16, v192
    v_lshl_or_b32 v145, v195, 16, v194
    v_lshl_or_b32 v146, v197, 16, v196
    v_lshl_or_b32 v147, v199, 16, v198
    v_lshl_or_b32 v148, v201, 16, v200
    v_lshl_or_b32 v149, v203, 16, v202
    v_lshl_or_b32 v150, v205, 16, v204
    v_lshl_or_b32 v151, v207, 16, v206
    v_lshl_or_b32 v152, v209, 16, v208
    v_lshl_or_b32 v153, v211, 16, v210
    v_lshl_or_b32 v154, v213, 16, v212
    v_lshl_or_b32 v155, v215, 16, v214
    v_lshl_or_b32 v156, v217, 16, v216
    v_lshl_or_b32 v157, v219, 16, v218
    v_lshl_or_b32 v158, v221, 16, v220
    v_lshl_or_b32 v159, v223, 16, v222
    buffer_load_ushort v192, v13, s[24:27], s46 offen offset:128
    buffer_load_ushort v193, v13, s[24:27], s46 offen offset:384
    buffer_load_ushort v194, v13, s[24:27], s46 offen offset:640
    buffer_load_ushort v195, v13, s[24:27], s46 offen offset:896
    buffer_load_ushort v196, v13, s[24:27], s47 offen offset:128
    buffer_load_ushort v197, v13, s[24:27], s47 offen offset:384
    buffer_load_ushort v198, v13, s[24:27], s47 offen offset:640
    buffer_load_ushort v199, v13, s[24:27], s47 offen offset:896
    buffer_load_ushort v200, v13, s[24:27], s46 offen offset:160
    buffer_load_ushort v201, v13, s[24:27], s46 offen offset:416
    buffer_load_ushort v202, v13, s[24:27], s46 offen offset:672
    buffer_load_ushort v203, v13, s[24:27], s46 offen offset:928
    buffer_load_ushort v204, v13, s[24:27], s47 offen offset:160
    buffer_load_ushort v205, v13, s[24:27], s47 offen offset:416
    buffer_load_ushort v206, v13, s[24:27], s47 offen offset:672
    buffer_load_ushort v207, v13, s[24:27], s47 offen offset:928
    buffer_load_ushort v208, v13, s[24:27], s46 offen offset:192
    buffer_load_ushort v209, v13, s[24:27], s46 offen offset:448
    buffer_load_ushort v210, v13, s[24:27], s46 offen offset:704
    buffer_load_ushort v211, v13, s[24:27], s46 offen offset:960
    buffer_load_ushort v212, v13, s[24:27], s47 offen offset:192
    buffer_load_ushort v213, v13, s[24:27], s47 offen offset:448
    buffer_load_ushort v214, v13, s[24:27], s47 offen offset:704
    buffer_load_ushort v215, v13, s[24:27], s47 offen offset:960
    buffer_load_ushort v216, v13, s[24:27], s46 offen offset:224
    buffer_load_ushort v217, v13, s[24:27], s46 offen offset:480
    buffer_load_ushort v218, v13, s[24:27], s46 offen offset:736
    buffer_load_ushort v219, v13, s[24:27], s46 offen offset:992
    buffer_load_ushort v220, v13, s[24:27], s47 offen offset:224
    buffer_load_ushort v221, v13, s[24:27], s47 offen offset:480
    buffer_load_ushort v222, v13, s[24:27], s47 offen offset:736
    buffer_load_ushort v223, v13, s[24:27], s47 offen offset:992
    s_waitcnt vmcnt(0)
    v_lshl_or_b32 v176, v193, 16, v192
    v_lshl_or_b32 v177, v195, 16, v194
    v_lshl_or_b32 v178, v197, 16, v196
    v_lshl_or_b32 v179, v199, 16, v198
    v_lshl_or_b32 v180, v201, 16, v200
    v_lshl_or_b32 v181, v203, 16, v202
    v_lshl_or_b32 v182, v205, 16, v204
    v_lshl_or_b32 v183, v207, 16, v206
    v_lshl_or_b32 v184, v209, 16, v208
    v_lshl_or_b32 v185, v211, 16, v210
    v_lshl_or_b32 v186, v213, 16, v212
    v_lshl_or_b32 v187, v215, 16, v214
    v_lshl_or_b32 v188, v217, 16, v216
    v_lshl_or_b32 v189, v219, 16, v218
    v_lshl_or_b32 v190, v221, 16, v220
    v_lshl_or_b32 v191, v223, 16, v222
    v_max3_f32 v30, v128, v129, v130
    v_max3_f32 v30, v30, v131, v132
    v_max3_f32 v30, v30, v133, v134
    v_max_f32 v30, v30, v135
    v_mov_b32 v31, v30
    s_nop 1
    v_permlane32_swap_b32 v30, v31
    v_max_f32 v30, v30, v31
    v_mov_b32 v31, v30
    s_nop 1
    v_permlane16_swap_b32 v30, v31
    v_max3_f32 v30, v30, v31, v14
    v_sub_f32 v31, v14, v30
    v_exp_f32 v31, v31
    v_mov_b32 v14, v30
    v_sub_f32 v128, v128, v30
    v_sub_f32 v129, v129, v30
    v_sub_f32 v130, v130, v30
    v_sub_f32 v131, v131, v30
    v_sub_f32 v132, v132, v30
    v_sub_f32 v133, v133, v30
    v_sub_f32 v134, v134, v30
    v_sub_f32 v135, v135, v30
    v_exp_f32 v128, v128
    v_exp_f32 v129, v129
    v_exp_f32 v130, v130
    v_exp_f32 v131, v131
    v_exp_f32 v132, v132
    v_exp_f32 v133, v133
    v_exp_f32 v134, v134
    v_exp_f32 v135, v135
    v_mul_f32 v28, v28, v31
    v_add_f32 v28, v28, v128
    v_add_f32 v28, v28, v129
    v_add_f32 v28, v28, v130
    v_add_f32 v28, v28, v131
    v_add_f32 v28, v28, v132
    v_add_f32 v28, v28, v133
    v_add_f32 v28, v28, v134
    v_add_f32 v28, v28, v135
    v_cvt_pk_bf16_f32 v160, v128, v129
    v_cvt_pk_bf16_f32 v161, v130, v131
    v_cvt_pk_bf16_f32 v162, v132, v133
    v_cvt_pk_bf16_f32 v163, v134, v135
    v_mul_f32 v64, v64, v31
    v_mul_f32 v65, v65, v31
    v_mul_f32 v66, v66, v31
    v_mul_f32 v67, v67, v31
    v_mul_f32 v68, v68, v31
    v_mul_f32 v69, v69, v31
    v_mul_f32 v70, v70, v31
    v_mul_f32 v71, v71, v31
    v_mul_f32 v80, v80, v31
    v_mul_f32 v81, v81, v31
    v_mul_f32 v82, v82, v31
    v_mul_f32 v83, v83, v31
    v_mul_f32 v84, v84, v31
    v_mul_f32 v85, v85, v31
    v_mul_f32 v86, v86, v31
    v_mul_f32 v87, v87, v31
    v_mul_f32 v96, v96, v31
    v_mul_f32 v97, v97, v31
    v_mul_f32 v98, v98, v31
    v_mul_f32 v99, v99, v31
    v_mul_f32 v100, v100, v31
    v_mul_f32 v101, v101, v31
    v_mul_f32 v102, v102, v31
    v_mul_f32 v103, v103, v31
    v_mul_f32 v112, v112, v31
    v_mul_f32 v113, v113, v31
    v_mul_f32 v114, v114, v31
    v_mul_f32 v115, v115, v31
    v_mul_f32 v116, v116, v31
    v_mul_f32 v117, v117, v31
    v_mul_f32 v118, v118, v31
    v_mul_f32 v119, v119, v31
    v_max3_f32 v30, v136, v137, v138
    v_max3_f32 v30, v30, v139, v140
    v_max3_f32 v30, v30, v141, v142
    v_max_f32 v30, v30, v143
    v_mov_b32 v31, v30
    s_nop 1
    v_permlane32_swap_b32 v30, v31
    v_max_f32 v30, v30, v31
    v_mov_b32 v31, v30
    s_nop 1
    v_permlane16_swap_b32 v30, v31
    v_max3_f32 v30, v30, v31, v15
    v_sub_f32 v31, v15, v30
    v_exp_f32 v31, v31
    v_mov_b32 v15, v30
    v_sub_f32 v136, v136, v30
    v_sub_f32 v137, v137, v30
    v_sub_f32 v138, v138, v30
    v_sub_f32 v139, v139, v30
    v_sub_f32 v140, v140, v30
    v_sub_f32 v141, v141, v30
    v_sub_f32 v142, v142, v30
    v_sub_f32 v143, v143, v30
    v_exp_f32 v136, v136
    v_exp_f32 v137, v137
    v_exp_f32 v138, v138
    v_exp_f32 v139, v139
    v_exp_f32 v140, v140
    v_exp_f32 v141, v141
    v_exp_f32 v142, v142
    v_exp_f32 v143, v143
    v_mul_f32 v29, v29, v31
    v_add_f32 v29, v29, v136
    v_add_f32 v29, v29, v137
    v_add_f32 v29, v29, v138
    v_add_f32 v29, v29, v139
    v_add_f32 v29, v29, v140
    v_add_f32 v29, v29, v141
    v_add_f32 v29, v29, v142
    v_add_f32 v29, v29, v143
    v_cvt_pk_bf16_f32 v164, v136, v137
    v_cvt_pk_bf16_f32 v165, v138, v139
    v_cvt_pk_bf16_f32 v166, v140, v141
    v_cvt_pk_bf16_f32 v167, v142, v143
    v_mul_f32 v72, v72, v31
    v_mul_f32 v73, v73, v31
    v_mul_f32 v74, v74, v31
    v_mul_f32 v75, v75, v31
    v_mul_f32 v76, v76, v31
    v_mul_f32 v77, v77, v31
    v_mul_f32 v78, v78, v31
    v_mul_f32 v79, v79, v31
    v_mul_f32 v88, v88, v31
    v_mul_f32 v89, v89, v31
    v_mul_f32 v90, v90, v31
    v_mul_f32 v91, v91, v31
    v_mul_f32 v92, v92, v31
    v_mul_f32 v93, v93, v31
    v_mul_f32 v94, v94, v31
    v_mul_f32 v95, v95, v31
    v_mul_f32 v104, v104, v31
    v_mul_f32 v105, v105, v31
    v_mul_f32 v106, v106, v31
    v_mul_f32 v107, v107, v31
    v_mul_f32 v108, v108, v31
    v_mul_f32 v109, v109, v31
    v_mul_f32 v110, v110, v31
    v_mul_f32 v111, v111, v31
    v_mul_f32 v120, v120, v31
    v_mul_f32 v121, v121, v31
    v_mul_f32 v122, v122, v31
    v_mul_f32 v123, v123, v31
    v_mul_f32 v124, v124, v31
    v_mul_f32 v125, v125, v31
    v_mul_f32 v126, v126, v31
    v_mul_f32 v127, v127, v31
    v_mfma_f32_16x16x32_bf16 v[64:67], v[144:147], v[160:163], v[64:67]
    v_mfma_f32_16x16x32_bf16 v[72:75], v[144:147], v[164:167], v[72:75]
    v_mfma_f32_16x16x32_bf16 v[68:71], v[148:151], v[160:163], v[68:71]
    v_mfma_f32_16x16x32_bf16 v[76:79], v[148:151], v[164:167], v[76:79]
    v_mfma_f32_16x16x32_bf16 v[80:83], v[152:155], v[160:163], v[80:83]
    v_mfma_f32_16x16x32_bf16 v[88:91], v[152:155], v[164:167], v[88:91]
    v_mfma_f32_16x16x32_bf16 v[84:87], v[156:159], v[160:163], v[84:87]
    v_mfma_f32_16x16x32_bf16 v[92:95], v[156:159], v[164:167], v[92:95]
    v_mfma_f32_16x16x32_bf16 v[96:99], v[176:179], v[160:163], v[96:99]
    v_mfma_f32_16x16x32_bf16 v[104:107], v[176:179], v[164:167], v[104:107]
    v_mfma_f32_16x16x32_bf16 v[100:103], v[180:183], v[160:163], v[100:103]
    v_mfma_f32_16x16x32_bf16 v[108:111], v[180:183], v[164:167], v[108:111]
    v_mfma_f32_16x16x32_bf16 v[112:115], v[184:187], v[160:163], v[112:115]
    v_mfma_f32_16x16x32_bf16 v[120:123], v[184:187], v[164:167], v[120:123]
    v_mfma_f32_16x16x32_bf16 v[116:119], v[188:191], v[160:163], v[116:119]
    v_mfma_f32_16x16x32_bf16 v[124:127], v[188:191], v[164:167], v[124:127]
    s_add_u32 s46, s46, 8192
    s_cmp_lt_u32 s46, 262144
    s_cbranch_scc1 L_fb_loop
    v_permlane32_swap_b32 v28, v29
    v_add_f32 v28, v28, v29
    v_mov_b32 v29, v28
    s_nop 1
    v_permlane16_swap_b32 v28, v29
    v_add_f32 v30, v28, v29
    v_rcp_f32 v28, v30
    s_nop 0
    v_mov_b32 v29, v28
    s_nop 1
    v_permlane32_swap_b32 v28, v29
    v_mul_f32 v64, v64, v28
    v_mul_f32 v65, v65, v28
    v_mul_f32 v66, v66, v28
    v_mul_f32 v67, v67, v28
    v_mul_f32 v68, v68, v28
    v_mul_f32 v69, v69, v28
    v_mul_f32 v70, v70, v28
    v_mul_f32 v71, v71, v28
    v_cvt_pk_bf16_f32 v64, v64, v65
    v_cvt_pk_bf16_f32 v65, v66, v67
    v_cvt_pk_bf16_f32 v66, v68, v69
    v_cvt_pk_bf16_f32 v67, v70, v71
    buffer_store_dwordx4 v[64:67], v1, s[12:15], s54 offen offset:0
    v_mul_f32 v72, v72, v29
    v_mul_f32 v73, v73, v29
    v_mul_f32 v74, v74, v29
    v_mul_f32 v75, v75, v29
    v_mul_f32 v76, v76, v29
    v_mul_f32 v77, v77, v29
    v_mul_f32 v78, v78, v29
    v_mul_f32 v79, v79, v29
    v_cvt_pk_bf16_f32 v72, v72, v73
    v_cvt_pk_bf16_f32 v73, v74, v75
    v_cvt_pk_bf16_f32 v74, v76, v77
    v_cvt_pk_bf16_f32 v75, v78, v79
    buffer_store_dwordx4 v[72:75], v1, s[12:15], s54 offen offset:1024
    v_mul_f32 v80, v80, v28
    v_mul_f32 v81, v81, v28
    v_mul_f32 v82, v82, v28
    v_mul_f32 v83, v83, v28
    v_mul_f32 v84, v84, v28
    v_mul_f32 v85, v85, v28
    v_mul_f32 v86, v86, v28
    v_mul_f32 v87, v87, v28
    v_cvt_pk_bf16_f32 v80, v80, v81
    v_cvt_pk_bf16_f32 v81, v82, v83
    v_cvt_pk_bf16_f32 v82, v84, v85
    v_cvt_pk_bf16_f32 v83, v86, v87
    buffer_store_dwordx4 v[80:83], v1, s[12:15], s54 offen offset:2048
    v_mul_f32 v88, v88, v29
    v_mul_f32 v89, v89, v29
    v_mul_f32 v90, v90, v29
    v_mul_f32 v91, v91, v29
    v_mul_f32 v92, v92, v29
    v_mul_f32 v93, v93, v29
    v_mul_f32 v94, v94, v29
    v_mul_f32 v95, v95, v29
    v_cvt_pk_bf16_f32 v88, v88, v89
    v_cvt_pk_bf16_f32 v89, v90, v91
    v_cvt_pk_bf16_f32 v90, v92, v93
    v_cvt_pk_bf16_f32 v91, v94, v95
    buffer_store_dwordx4 v[88:91], v1, s[12:15], s54 offen offset:3072
    v_mul_f32 v96, v96, v28
    v_mul_f32 v97, v97, v28
    v_mul_f32 v98, v98, v28
    v_mul_f32 v99, v99, v28
    v_mul_f32 v100, v100, v28
    v_mul_f32 v101, v101, v28
    v_mul_f32 v102, v102, v28
    v_mul_f32 v103, v103, v28
    v_cvt_pk_bf16_f32 v96, v96, v97
    v_cvt_pk_bf16_f32 v97, v98, v99
    v_cvt_pk_bf16_f32 v98, v100, v101
    v_cvt_pk_bf16_f32 v99, v102, v103
    buffer_store_dwordx4 v[96:99], v1, s[12:15], s55 offen offset:0
    v_mul_f32 v104, v104, v29
    v_mul_f32 v105, v105, v29
    v_mul_f32 v106, v106, v29
    v_mul_f32 v107, v107, v29
    v_mul_f32 v108, v108, v29
    v_mul_f32 v109, v109, v29
    v_mul_f32 v110, v110, v29
    v_mul_f32 v111, v111, v29
    v_cvt_pk_bf16_f32 v104, v104, v105
    v_cvt_pk_bf16_f32 v105, v106, v107
    v_cvt_pk_bf16_f32 v106, v108, v109
    v_cvt_pk_bf16_f32 v107, v110, v111
    buffer_store_dwordx4 v[104:107], v1, s[12:15], s55 offen offset:1024
    v_mul_f32 v112, v112, v28
    v_mul_f32 v113, v113, v28
    v_mul_f32 v114, v114, v28
    v_mul_f32 v115, v115, v28
    v_mul_f32 v116, v116, v28
    v_mul_f32 v117, v117, v28
    v_mul_f32 v118, v118, v28
    v_mul_f32 v119, v119, v28
    v_cvt_pk_bf16_f32 v112, v112, v113
    v_cvt_pk_bf16_f32 v113, v114, v115
    v_cvt_pk_bf16_f32 v114, v116, v117
    v_cvt_pk_bf16_f32 v115, v118, v119
    buffer_store_dwordx4 v[112:115], v1, s[12:15], s55 offen offset:2048
    v_mul_f32 v120, v120, v29
    v_mul_f32 v121, v121, v29
    v_mul_f32 v122, v122, v29
    v_mul_f32 v123, v123, v29
    v_mul_f32 v124, v124, v29
    v_mul_f32 v125, v125, v29
    v_mul_f32 v126, v126, v29
    v_mul_f32 v127, v127, v29
    v_cvt_pk_bf16_f32 v120, v120, v121
    v_cvt_pk_bf16_f32 v121, v122, v123
    v_cvt_pk_bf16_f32 v122, v124, v125
    v_cvt_pk_bf16_f32 v123, v126, v127
    buffer_store_dwordx4 v[120:123], v1, s[12:15], s55 offen offset:3072
    s_branch L_fb_ret
L_end:
    s_endpgm
.section .rodata,"a"
.p2align 6
.amdhsa_kernel concat_heads__gqa_block_cached__gqa_block_cached__near_ridge_kernel
  .amdhsa_next_free_vgpr 256
  .amdhsa_next_free_sgpr 100
  .amdhsa_accum_offset 256
  .amdhsa_group_segment_fixed_size 0
  .amdhsa_kernarg_size 104
  .amdhsa_user_sgpr_count 2
  .amdhsa_user_sgpr_kernarg_segment_ptr 1
  .amdhsa_system_sgpr_workgroup_id_x 1
.end_amdhsa_kernel
```
